```python
import torch

def _softmax(x, axis=-1):
    return torch.softmax(x, dim=axis)
def _gelu(x):
    return torch.nn.functional.gelu(x, approximate="tanh")
def _silu(x):
    return torch.nn.functional.silu(x)
def _sigmoid(x):
    return torch.sigmoid(x)
def _layernorm(x, axis=-1, eps=1e-5):
    m = x.mean(dim=axis, keepdim=True)
    v = x.var(dim=axis, keepdim=True, unbiased=False)
    return (x - m) / torch.sqrt(v + eps)
def _scatter_add(tgt, idx, src, axis=0):
    return tgt.clone().index_add_(axis, idx, src)
def _segment_sum(src, seg, n):
    out = torch.zeros((n,) + src.shape[1:], dtype=src.dtype)
    return out.index_add_(0, seg, src)
def _pad(x, pw):
    flat = tuple(v for pair in reversed(pw) for v in pair)
    return torch.nn.functional.pad(x, flat)

kernel_name = 'parallel_sum__mha_block_cached__dense_activation_relu__decode'

def setup_inputs():

    _w = (lambda a: (lambda t: t.to(torch.bfloat16) if t.is_floating_point() else t)(torch.as_tensor(a)))
    def _A_setup():
        B, Sq, D = 2, 1, 640
        H, Sk, Dh = 32, 8192, 192
        return {
            "x": _w((lambda *s: torch.randn(*s, dtype=torch.bfloat16) * 0.05)(B, Sq, D)),
            "k_cache": _w((lambda *s: torch.randn(*s, dtype=torch.bfloat16) * 3.2)(B, H, Sk, Dh)),
            "v_cache": _w((lambda *s: torch.randn(*s, dtype=torch.bfloat16) * 1.6)(B, H, Sk, Dh)),
            "wq": _w((lambda *s: torch.randn(*s, dtype=torch.bfloat16) * 3.2)(D, H * Dh) * (D ** -0.5)),
            "wo": _w((lambda *s: torch.randn(*s, dtype=torch.bfloat16) * 1.6)(H * Dh, D) * ((H * Dh) ** -0.5)),
        }
    _A_in = _A_setup()

    def _B_setup():
        B, S, D, Dff = 2, 1, 640, 1536
        return {
            "x": _w((lambda *s: torch.randn(*s, dtype=torch.bfloat16) * 0.05)(B, S, D)),
            "w1": _w((lambda *s: torch.randn(*s, dtype=torch.bfloat16) * 0.05)(D, Dff)),
            "w2": _w((lambda *s: torch.randn(*s, dtype=torch.bfloat16) * 0.05)(Dff, D)),
        }
    _B_in = _B_setup()

    return {
        "A_x": _A_in["x"],
        "A_k_cache": _A_in["k_cache"],
        "A_v_cache": _A_in["v_cache"],
        "A_wq": _A_in["wq"],
        "A_wo": _A_in["wo"],
        "B_x": _B_in["x"],
        "B_w1": _B_in["w1"],
        "B_w2": _B_in["w2"],
    }

def reference(A_x, A_k_cache, A_v_cache, A_wq, A_wo, B_x, B_w1, B_w2):
    def _A_ref(x, k_cache, v_cache, wq, wo):
        B, Sq, D = x.shape
        H, Dh = 32, 192
        q = (lambda x, *d: x.permute(*d))((x @ wq).reshape(B, Sq, H, Dh), 0, 2, 1, 3)
        scores = torch.einsum("bhqd,bhkd->bhqk", q, k_cache) * (Dh ** -0.5)
        p = _softmax(scores, axis=-1)
        o = torch.einsum("bhqk,bhkd->bhqd", p, v_cache)
        return (lambda x, *d: x.permute(*d))(o, 0, 2, 1, 3).reshape(B, Sq, H * Dh) @ wo

    def _B_ref(x, w1, w2):
        h = torch.einsum("bsd,df->bsf", x, w1)
        zero = torch.zeros_like(h)
        h = torch.maximum(h, zero)
        return torch.einsum("bsf,fd->bsd", h, w2)

    x = A_x
    xn = _layernorm(x, axis=-1)
    return x + _A_ref(xn, A_k_cache, A_v_cache, A_wq, A_wo) + _B_ref(xn, B_w1, B_w2)
```

```asm
; @launch grid=(256,1,1) block=(512,1,1) lds=42240
.amdgcn_target "amdgcn-amd-amdhsa--gfx950"
.text
.globl parallel_sum__mha_block_cached__dense_activation_relu__decode_kernel
.p2align 8
.type parallel_sum__mha_block_cached__dense_activation_relu__decode_kernel,@function
parallel_sum__mha_block_cached__dense_activation_relu__decode_kernel:
    s_cmp_ge_u32 s2, 256
    s_cbranch_scc1 L_end
    s_load_dwordx16 s[16:31], s[0:1], 0
    s_load_dwordx2 s[32:33], s[0:1], 64
    s_load_dwordx2 s[34:35], s[0:1], 80
    v_lshrrev_b32 v2, 6, v0
    v_and_b32 v1, 63, v0
    v_readfirstlane_b32 s3, v2
    s_and_b32 s10, s2, 7
    s_lshl_b32 s10, s10, 1
    s_lshr_b32 s11, s2, 7
    s_add_u32 s4, s10, s11
    s_bfe_u32 s7, s2, 0x40003
    s_and_b32 s8, s3, 3
    v_lshrrev_b32 v3, 4, v1
    s_mov_b32 s39, 0x20000
    s_cmp_lt_u32 s3, 4
    s_cbranch_scc1 L_helper
    v_lshrrev_b32 v2, 3, v1
    v_mul_u32_u24 v2, 384, v2
    v_and_b32 v10, 7, v1
    v_lshl_add_u32 v2, v10, 4, v2
    s_lshl_b32 s10, s7, 2
    s_add_u32 s10, s10, s8
    s_mul_i32 s12, s10, 3072
    s_mul_i32 s10, s4, 3145728
    s_add_u32 s12, s12, s10
    s_mov_b32 s38, 201326592
    s_mov_b32 s40, s7
    s_mov_b32 s42, 208896
    s_lshl_b32 s58, s4, 2
    s_mov_b32 s56, 0xb190b19f
    s_mov_b32 s57, 0xa3a1c39f
    s_lshr_b64 s[56:57], s[56:57], s58
    s_and_b32 s54, s56, 15
    s_mul_i32 s10, s54, 196608
    s_add_u32 s12, s12, s10
    s_mov_b32 s55, s54
    s_waitcnt lgkmcnt(0)
    s_mov_b32 s36, s18
    s_mov_b32 s37, s19
    buffer_load_dwordx4 v[44:47], v2, s[36:39], s12 offen offset:0 nt
    buffer_load_dwordx4 v[48:51], v2, s[36:39], s12 offen offset:128 nt
    buffer_load_dwordx4 v[52:55], v2, s[36:39], s12 offen offset:256 nt
    s_add_u32 s40, s40, 1
    s_and_b32 s40, s40, 15
    s_cselect_b32 s41, s42, 12288
    s_add_u32 s12, s12, s41
    s_add_u32 s54, s54, 1
    s_and_b32 s54, s54, 15
    s_cselect_b32 s41, 0, 3145728
    s_sub_u32 s12, s12, s41
    buffer_load_dwordx4 v[56:59], v2, s[36:39], s12 offen offset:0 nt
    buffer_load_dwordx4 v[60:63], v2, s[36:39], s12 offen offset:128 nt
    buffer_load_dwordx4 v[64:67], v2, s[36:39], s12 offen offset:256 nt
    s_add_u32 s40, s40, 1
    s_and_b32 s40, s40, 15
    s_cselect_b32 s41, s42, 12288
    s_add_u32 s12, s12, s41
    s_add_u32 s54, s54, 1
    s_and_b32 s54, s54, 15
    s_cselect_b32 s41, 0, 3145728
    s_sub_u32 s12, s12, s41
    buffer_load_dwordx4 v[68:71], v2, s[36:39], s12 offen offset:0 nt
    s_barrier
    s_branch L_stream
L_helper:
    s_cmp_eq_u32 s3, 0
    s_cbranch_scc1 L_h0
    v_mov_b32 v8, 0
    v_mov_b32 v9, 0
    v_mov_b32 v10, 0
    v_mov_b32 v11, 0
    ds_write_b128 v8, v[8:11] offset:1792
    ds_write_b128 v8, v[8:11] offset:1808
    ds_write_b128 v8, v[8:11] offset:1824
    ds_write_b128 v8, v[8:11] offset:1840
    ds_write_b128 v8, v[8:11] offset:1856
    ds_write_b128 v8, v[8:11] offset:1872
    s_waitcnt lgkmcnt(0)
    s_cmp_lg_u32 s3, 1
    s_cbranch_scc1 L_noz
    s_cmp_ge_u32 s2, 16
    s_cbranch_scc1 L_noz
    s_mov_b32 s44, s34
    s_mov_b32 s45, s35
    s_mov_b32 s46, 4194304
    s_mov_b32 s47, 0x20000
    s_mul_i32 s10, s2, 8448
    s_add_u32 s10, s10, 1310720
    s_mov_b64 exec, 1
    buffer_store_dword v8, v8, s[44:47], s10 offen sc1
    s_mov_b64 exec, -1
L_noz:
    s_barrier
    s_branch L_h123
L_h0:
    s_setprio 3
    s_mul_i32 s11, s11, 15
    s_add_u32 s11, s11, s7
    s_sub_u32 s11, s11, 1
    s_add_u32 s57, s2, 1
    s_and_b32 s57, s57, 7
    s_mul_i32 s57, s57, 12
    s_cmp_ge_u32 s11, 12
    s_cselect_b32 s58, 84, 0
    s_add_u32 s57, s57, s58
    s_mul_i32 s10, s10, 3
    s_add_u32 s10, s10, 168
    s_cmp_lt_u32 s11, 24
    s_cselect_b32 s57, s57, s10
    s_cselect_b32 s56, 4, 1
    s_cselect_b32 s10, 0, 48
    s_add_u32 s57, s57, s11
    s_and_b32 s55, s57, 3
    s_lshr_b32 s57, s57, 2
    v_and_b32 v2, 7, v1
    v_lshl_add_u32 v2, v3, 3, v2
    v_lshlrev_b32 v2, 3, v2
    v_bfe_u32 v8, v1, 3, 1
    v_mul_u32_u24 v9, 1280, v8
    v_add_u32 v9, v9, v2
    s_mov_b32 s50, 2560
    s_mov_b32 s51, 0x20000
    s_mul_i32 s38, s56, 1966080
    s_mul_i32 s56, s56, 3072
    s_mul_i32 s11, s56, 40
    v_mul_lo_u32 v24, v3, s11
    v_and_b32 v25, 15, v1
    v_lshl_add_u32 v24, v25, 4, v24
    s_mul_i32 s58, s55, 320
    s_sub_u32 s10, s57, s10
    s_lshl_b32 s10, s10, 8
    s_lshl_b32 s11, s11, 2
    s_mul_i32 s11, s11, s55
    s_add_u32 s10, s10, s11
    s_cmp_lt_u32 s57, 48
    s_waitcnt lgkmcnt(0)
    s_cselect_b32 s36, s22, s28
    s_cselect_b32 s37, s23, s29
    s_mov_b32 s48, s16
    s_mov_b32 s49, s17
    s_load_dword s9, s[34:35], 0
    s_cmp_eq_u32 s7, 0
    s_cbranch_scc1 L_noP
    buffer_load_dwordx2 v[10:11], v9, s[48:51], 0 offen offset:0
    buffer_load_dwordx2 v[12:13], v9, s[48:51], 0 offen offset:256
    buffer_load_dwordx2 v[14:15], v9, s[48:51], 0 offen offset:512
    buffer_load_dwordx2 v[16:17], v9, s[48:51], 0 offen offset:768
    buffer_load_dwordx2 v[18:19], v9, s[48:51], 0 offen offset:1024
    buffer_load_dwordx2 v[20:21], v9, s[48:51], s58 offen offset:0
    buffer_load_dwordx2 v[22:23], v9, s[48:51], s58 offen offset:256
    buffer_load_dwordx4 v[64:67], v24, s[36:39], s10 offen nt
    s_add_u32 s10, s10, s56
    buffer_load_dwordx4 v[68:71], v24, s[36:39], s10 offen nt
    s_add_u32 s10, s10, s56
    buffer_load_dwordx4 v[72:75], v24, s[36:39], s10 offen nt
    s_add_u32 s10, s10, s56
    buffer_load_dwordx4 v[76:79], v24, s[36:39], s10 offen nt
    s_add_u32 s10, s10, s56
    buffer_load_dwordx4 v[80:83], v24, s[36:39], s10 offen nt
    s_add_u32 s10, s10, s56
    buffer_load_dwordx4 v[84:87], v24, s[36:39], s10 offen nt
    s_add_u32 s10, s10, s56
    buffer_load_dwordx4 v[88:91], v24, s[36:39], s10 offen nt
    s_add_u32 s10, s10, s56
    buffer_load_dwordx4 v[92:95], v24, s[36:39], s10 offen nt
    s_add_u32 s10, s10, s56
    s_barrier
    buffer_load_dwordx4 v[96:99], v24, s[36:39], s10 offen nt
    s_add_u32 s10, s10, s56
    buffer_load_dwordx4 v[100:103], v24, s[36:39], s10 offen nt
    s_add_u32 s10, s10, s56
    buffer_load_dwordx4 v[104:107], v24, s[36:39], s10 offen nt
    s_add_u32 s10, s10, s56
    buffer_load_dwordx4 v[108:111], v24, s[36:39], s10 offen nt
    s_add_u32 s10, s10, s56
    buffer_load_dwordx4 v[112:115], v24, s[36:39], s10 offen nt
    s_add_u32 s10, s10, s56
    buffer_load_dwordx4 v[116:119], v24, s[36:39], s10 offen nt
    s_add_u32 s10, s10, s56
    buffer_load_dwordx4 v[120:123], v24, s[36:39], s10 offen nt
    s_add_u32 s10, s10, s56
    buffer_load_dwordx4 v[124:127], v24, s[36:39], s10 offen nt
    s_add_u32 s10, s10, s56
    buffer_load_dwordx4 v[128:131], v24, s[36:39], s10 offen nt
    s_add_u32 s10, s10, s56
    buffer_load_dwordx4 v[132:135], v24, s[36:39], s10 offen nt
    s_add_u32 s10, s10, s56
    buffer_load_dwordx4 v[136:139], v24, s[36:39], s10 offen nt
    s_add_u32 s10, s10, s56
    buffer_load_dwordx4 v[140:143], v24, s[36:39], s10 offen nt
    s_add_u32 s10, s10, s56
    buffer_load_dwordx4 v[144:147], v24, s[36:39], s10 offen nt
    s_add_u32 s10, s10, s56
    buffer_load_dwordx4 v[148:151], v24, s[36:39], s10 offen nt
    s_add_u32 s10, s10, s56
    buffer_load_dwordx4 v[152:155], v24, s[36:39], s10 offen nt
    s_add_u32 s10, s10, s56
    buffer_load_dwordx4 v[156:159], v24, s[36:39], s10 offen nt
    s_add_u32 s10, s10, s56
    buffer_load_dwordx4 v[160:163], v24, s[36:39], s10 offen nt
    s_add_u32 s10, s10, s56
    buffer_load_dwordx4 v[164:167], v24, s[36:39], s10 offen nt
    s_add_u32 s10, s10, s56
    buffer_load_dwordx4 v[168:171], v24, s[36:39], s10 offen nt
    s_add_u32 s10, s10, s56
    buffer_load_dwordx4 v[172:175], v24, s[36:39], s10 offen nt
    s_add_u32 s10, s10, s56
    buffer_load_dwordx4 v[176:179], v24, s[36:39], s10 offen nt
    s_add_u32 s10, s10, s56
    buffer_load_dwordx4 v[180:183], v24, s[36:39], s10 offen nt
    s_add_u32 s10, s10, s56
    buffer_load_dwordx4 v[184:187], v24, s[36:39], s10 offen nt
    s_add_u32 s10, s10, s56
    buffer_load_dwordx4 v[188:191], v24, s[36:39], s10 offen nt
    s_add_u32 s10, s10, s56
    buffer_load_dwordx4 v[192:195], v24, s[36:39], s10 offen nt
    s_add_u32 s10, s10, s56
    buffer_load_dwordx4 v[196:199], v24, s[36:39], s10 offen nt
    s_add_u32 s10, s10, s56
    buffer_load_dwordx4 v[200:203], v24, s[36:39], s10 offen nt
    s_add_u32 s10, s10, s56
    buffer_load_dwordx4 v[204:207], v24, s[36:39], s10 offen nt
    s_add_u32 s10, s10, s56
    buffer_load_dwordx4 v[208:211], v24, s[36:39], s10 offen nt
    s_add_u32 s10, s10, s56
    buffer_load_dwordx4 v[212:215], v24, s[36:39], s10 offen nt
    s_add_u32 s10, s10, s56
    buffer_load_dwordx4 v[216:219], v24, s[36:39], s10 offen nt
    s_add_u32 s10, s10, s56
    buffer_load_dwordx4 v[220:223], v24, s[36:39], s10 offen nt
    v_and_b32 v26, 1, v1
    v_lshlrev_b32 v26, 4, v26
    v_mov_b32 v27, 0xffff
    v_lshlrev_b32 v27, v26, v27
    v_bfe_u32 v26, v1, 1, 2
    v_cmp_eq_u32 vcc, 0, v26
    s_nop 1
    v_cndmask_b32 v4, 0, v27, vcc
    v_cmp_eq_u32 vcc, 1, v26
    s_nop 1
    v_cndmask_b32 v5, 0, v27, vcc
    v_cmp_eq_u32 vcc, 2, v26
    s_nop 1
    v_cndmask_b32 v6, 0, v27, vcc
    v_cmp_eq_u32 vcc, 3, v26
    s_nop 1
    v_cndmask_b32 v7, 0, v27, vcc
    s_mov_b32 s44, s34
    s_mov_b32 s45, s35
    s_mov_b32 s46, 4194304
    s_mov_b32 s47, 0x20000
    s_mov_b32 s13, 0xffff0000
    s_mov_b32 s14, 0xfffffff0
    v_mov_b32 v25, 0x0c0c0c0c
    s_mov_b32 s10, 0x01000100
    s_mov_b32 s11, 0x03020302
    v_bfi_b32 v26, v4, s10, v25
    v_bfi_b32 v30, v4, s11, v25
    v_bfi_b32 v27, v5, s10, v25
    v_bfi_b32 v31, v5, s11, v25
    v_bfi_b32 v28, v6, s10, v25
    v_bfi_b32 v32, v6, s11, v25
    v_bfi_b32 v29, v7, s10, v25
    v_bfi_b32 v33, v7, s11, v25
    s_waitcnt vmcnt(42)
    v_lshlrev_b32 v36, 16, v10
    v_and_b32 v37, s13, v10
    v_lshlrev_b32 v38, 16, v11
    v_and_b32 v39, s13, v11
    v_lshlrev_b32 v40, 16, v12
    v_and_b32 v41, s13, v12
    v_lshlrev_b32 v42, 16, v13
    v_and_b32 v43, s13, v13
    v_lshlrev_b32 v44, 16, v14
    v_and_b32 v45, s13, v14
    v_lshlrev_b32 v46, 16, v15
    v_and_b32 v47, s13, v15
    v_lshlrev_b32 v48, 16, v16
    v_and_b32 v49, s13, v16
    v_lshlrev_b32 v50, 16, v17
    v_and_b32 v51, s13, v17
    v_lshlrev_b32 v52, 16, v18
    v_and_b32 v53, s13, v18
    v_lshlrev_b32 v54, 16, v19
    v_and_b32 v55, s13, v19
    v_add_f32 v34, v36, v38
    v_add_f32 v35, v37, v39
    v_add_f32 v34, v34, v40
    v_add_f32 v35, v35, v41
    v_add_f32 v34, v34, v42
    v_add_f32 v35, v35, v43
    v_add_f32 v34, v34, v44
    v_add_f32 v35, v35, v45
    v_add_f32 v34, v34, v46
    v_add_f32 v35, v35, v47
    v_add_f32 v34, v34, v48
    v_add_f32 v35, v35, v49
    v_add_f32 v34, v34, v50
    v_add_f32 v35, v35, v51
    v_add_f32 v34, v34, v52
    v_add_f32 v35, v35, v53
    v_add_f32 v34, v34, v54
    v_add_f32 v35, v35, v55
    v_add_f32 v34, v34, v35
    s_nop 1
    v_add_f32_dpp v34, v34, v34 quad_perm:[1,0,3,2] row_mask:0xf bank_mask:0xf
    s_nop 1
    v_add_f32_dpp v34, v34, v34 quad_perm:[2,3,0,1] row_mask:0xf bank_mask:0xf
    s_nop 1
    v_add_f32_dpp v34, v34, v34 row_half_mirror row_mask:0xf bank_mask:0xf
    v_mov_b32 v35, v34
    s_nop 1
    v_permlane16_swap_b32 v34, v35
    v_add_f32 v34, v34, v35
    v_mov_b32 v35, v34
    s_nop 1
    v_permlane32_swap_b32 v34, v35
    v_add_f32 v34, v34, v35
    s_mov_b32 s10, 0x3acccccd
    v_mul_f32 v34, s10, v34
    v_sub_f32 v36, v36, v34
    v_sub_f32 v37, v37, v34
    v_sub_f32 v38, v38, v34
    v_sub_f32 v39, v39, v34
    v_sub_f32 v40, v40, v34
    v_sub_f32 v41, v41, v34
    v_sub_f32 v42, v42, v34
    v_sub_f32 v43, v43, v34
    v_sub_f32 v44, v44, v34
    v_sub_f32 v45, v45, v34
    v_sub_f32 v46, v46, v34
    v_sub_f32 v47, v47, v34
    v_sub_f32 v48, v48, v34
    v_sub_f32 v49, v49, v34
    v_sub_f32 v50, v50, v34
    v_sub_f32 v51, v51, v34
    v_sub_f32 v52, v52, v34
    v_sub_f32 v53, v53, v34
    v_sub_f32 v54, v54, v34
    v_sub_f32 v55, v55, v34
    v_mul_f32 v56, v36, v36
    v_mul_f32 v57, v37, v37
    v_fmac_f32 v56, v38, v38
    v_fmac_f32 v57, v39, v39
    v_fmac_f32 v56, v40, v40
    v_fmac_f32 v57, v41, v41
    v_fmac_f32 v56, v42, v42
    v_fmac_f32 v57, v43, v43
    v_fmac_f32 v56, v44, v44
    v_fmac_f32 v57, v45, v45
    v_fmac_f32 v56, v46, v46
    v_fmac_f32 v57, v47, v47
    v_fmac_f32 v56, v48, v48
    v_fmac_f32 v57, v49, v49
    v_fmac_f32 v56, v50, v50
    v_fmac_f32 v57, v51, v51
    v_fmac_f32 v56, v52, v52
    v_fmac_f32 v57, v53, v53
    v_fmac_f32 v56, v54, v54
    v_fmac_f32 v57, v55, v55
    v_add_f32 v56, v56, v57
    s_nop 1
    v_add_f32_dpp v56, v56, v56 quad_perm:[1,0,3,2] row_mask:0xf bank_mask:0xf
    s_nop 1
    v_add_f32_dpp v56, v56, v56 quad_perm:[2,3,0,1] row_mask:0xf bank_mask:0xf
    s_nop 1
    v_add_f32_dpp v56, v56, v56 row_half_mirror row_mask:0xf bank_mask:0xf
    v_mov_b32 v57, v56
    s_nop 1
    v_permlane16_swap_b32 v56, v57
    v_add_f32 v56, v56, v57
    v_mov_b32 v57, v56
    s_nop 1
    v_permlane32_swap_b32 v56, v57
    v_add_f32 v56, v56, v57
    v_mul_f32 v56, s10, v56
    v_cvt_pk_bf16_f32 v34, v34, v34
    v_and_b32 v34, s13, v34
    v_cvt_pk_bf16_f32 v56, v56, v56
    v_and_b32 v56, s13, v56
    v_add_f32 v56, 0x3727c5ac, v56
    v_cvt_pk_bf16_f32 v56, v56, v56
    v_and_b32 v56, s13, v56
    v_sqrt_f32 v56, v56
    s_nop 0
    v_cvt_pk_bf16_f32 v56, v56, v56
    v_and_b32 v56, s13, v56
    v_rcp_f32 v56, v56
    s_waitcnt vmcnt(40)
    v_lshlrev_b32 v36, 16, v20
    v_and_b32 v37, s13, v20
    v_sub_f32 v36, v36, v34
    v_sub_f32 v37, v37, v34
    v_cvt_pk_bf16_f32 v36, v36, v37
    v_and_b32 v37, s13, v36
    v_lshlrev_b32 v36, 16, v36
    v_mul_f32 v36, v36, v56
    v_mul_f32 v37, v37, v56
    v_cvt_pk_bf16_f32 v20, v36, v37
    v_lshlrev_b32 v36, 16, v21
    v_and_b32 v37, s13, v21
    v_sub_f32 v36, v36, v34
    v_sub_f32 v37, v37, v34
    v_cvt_pk_bf16_f32 v36, v36, v37
    v_and_b32 v37, s13, v36
    v_lshlrev_b32 v36, 16, v36
    v_mul_f32 v36, v36, v56
    v_mul_f32 v37, v37, v56
    v_cvt_pk_bf16_f32 v21, v36, v37
    v_lshlrev_b32 v36, 16, v22
    v_and_b32 v37, s13, v22
    v_sub_f32 v36, v36, v34
    v_sub_f32 v37, v37, v34
    v_cvt_pk_bf16_f32 v36, v36, v37
    v_and_b32 v37, s13, v36
    v_lshlrev_b32 v36, 16, v36
    v_mul_f32 v36, v36, v56
    v_mul_f32 v37, v37, v56
    v_cvt_pk_bf16_f32 v22, v36, v37
    v_lshlrev_b32 v36, 16, v23
    v_and_b32 v37, s13, v23
    v_sub_f32 v36, v36, v34
    v_sub_f32 v37, v37, v34
    v_cvt_pk_bf16_f32 v36, v36, v37
    v_and_b32 v37, s13, v36
    v_lshlrev_b32 v36, 16, v36
    v_mul_f32 v36, v36, v56
    v_mul_f32 v37, v37, v56
    v_cvt_pk_bf16_f32 v23, v36, v37
    v_lshl_add_u32 v36, v8, 9, v2
    ds_write_b64 v36, v[20:21] offset:2048
    ds_write_b64 v36, v[22:23] offset:2304
    v_mul_u32_u24 v36, 80, v3
    v_lshl_add_u32 v36, v8, 9, v36
    s_waitcnt lgkmcnt(0)
    s_add_u32 s9, s9, 0x11111111
    ds_read_b128 v[40:43], v36 offset:2048
    ds_read_b128 v[44:47], v36 offset:2064
    ds_read_b128 v[48:51], v36 offset:2080
    ds_read_b128 v[52:55], v36 offset:2096
    ds_read_b128 v[56:59], v36 offset:2112
    v_and_b32 v10, 16, v1
    v_bfe_u32 v12, s9, v10, 4
    v_add_u32 v13, 4, v10
    v_bfe_u32 v13, s9, v13, 4
    v_add_u32 v14, 8, v10
    v_bfe_u32 v14, s9, v14, 4
    v_add_u32 v15, 12, v10
    v_bfe_u32 v15, s9, v15, 4
    v_and_b32 v11, 15, v1
    v_lshl_add_u32 v10, v11, 5, v10
    v_lshrrev_b32 v11, 5, v1
    v_mul_u32_u24 v11, 30720, v11
    v_add_u32 v10, v10, v11
    s_mul_i32 s10, s55, 61440
    s_lshl_b32 s11, s57, 9
    s_add_u32 s10, s10, s11
    s_add_u32 s10, s10, 4096
    s_waitcnt lgkmcnt(0)
    v_perm_b32 v16, v40, v40, v26
    v_perm_b32 v17, v40, v40, v27
    v_perm_b32 v18, v40, v40, v28
    v_perm_b32 v19, v40, v40, v29
    s_waitcnt vmcnt(39)
    s_nop 0
    v_mfma_f32_16x16x32_bf16 v[60:63], v[16:19], v[64:67], 0
    v_perm_b32 v20, v40, v40, v30
    v_perm_b32 v21, v40, v40, v31
    v_perm_b32 v22, v40, v40, v32
    v_perm_b32 v23, v40, v40, v33
    s_waitcnt vmcnt(38)
    s_nop 0
    v_mfma_f32_16x16x32_bf16 v[60:63], v[20:23], v[68:71], v[60:63]
    v_perm_b32 v16, v41, v41, v26
    v_perm_b32 v17, v41, v41, v27
    v_perm_b32 v18, v41, v41, v28
    v_perm_b32 v19, v41, v41, v29
    s_waitcnt vmcnt(37)
    s_nop 0
    v_mfma_f32_16x16x32_bf16 v[60:63], v[16:19], v[72:75], v[60:63]
    v_perm_b32 v20, v41, v41, v30
    v_perm_b32 v21, v41, v41, v31
    v_perm_b32 v22, v41, v41, v32
    v_perm_b32 v23, v41, v41, v33
    s_waitcnt vmcnt(36)
    s_nop 0
    v_mfma_f32_16x16x32_bf16 v[60:63], v[20:23], v[76:79], v[60:63]
    v_perm_b32 v16, v42, v42, v26
    v_perm_b32 v17, v42, v42, v27
    v_perm_b32 v18, v42, v42, v28
    v_perm_b32 v19, v42, v42, v29
    s_waitcnt vmcnt(35)
    s_nop 0
    v_mfma_f32_16x16x32_bf16 v[60:63], v[16:19], v[80:83], v[60:63]
    v_perm_b32 v20, v42, v42, v30
    v_perm_b32 v21, v42, v42, v31
    v_perm_b32 v22, v42, v42, v32
    v_perm_b32 v23, v42, v42, v33
    s_waitcnt vmcnt(34)
    s_nop 0
    v_mfma_f32_16x16x32_bf16 v[60:63], v[20:23], v[84:87], v[60:63]
    v_perm_b32 v16, v43, v43, v26
    v_perm_b32 v17, v43, v43, v27
    v_perm_b32 v18, v43, v43, v28
    v_perm_b32 v19, v43, v43, v29
    s_waitcnt vmcnt(33)
    s_nop 0
    v_mfma_f32_16x16x32_bf16 v[60:63], v[16:19], v[88:91], v[60:63]
    v_perm_b32 v20, v43, v43, v30
    v_perm_b32 v21, v43, v43, v31
    v_perm_b32 v22, v43, v43, v32
    v_perm_b32 v23, v43, v43, v33
    s_waitcnt vmcnt(32)
    s_nop 0
    v_mfma_f32_16x16x32_bf16 v[60:63], v[20:23], v[92:95], v[60:63]
    v_perm_b32 v16, v44, v44, v26
    v_perm_b32 v17, v44, v44, v27
    v_perm_b32 v18, v44, v44, v28
    v_perm_b32 v19, v44, v44, v29
    s_waitcnt vmcnt(31)
    s_nop 0
    v_mfma_f32_16x16x32_bf16 v[60:63], v[16:19], v[96:99], v[60:63]
    v_perm_b32 v20, v44, v44, v30
    v_perm_b32 v21, v44, v44, v31
    v_perm_b32 v22, v44, v44, v32
    v_perm_b32 v23, v44, v44, v33
    s_waitcnt vmcnt(30)
    s_nop 0
    v_mfma_f32_16x16x32_bf16 v[60:63], v[20:23], v[100:103], v[60:63]
    v_perm_b32 v16, v45, v45, v26
    v_perm_b32 v17, v45, v45, v27
    v_perm_b32 v18, v45, v45, v28
    v_perm_b32 v19, v45, v45, v29
    s_waitcnt vmcnt(29)
    s_nop 0
    v_mfma_f32_16x16x32_bf16 v[60:63], v[16:19], v[104:107], v[60:63]
    v_perm_b32 v20, v45, v45, v30
    v_perm_b32 v21, v45, v45, v31
    v_perm_b32 v22, v45, v45, v32
    v_perm_b32 v23, v45, v45, v33
    s_waitcnt vmcnt(28)
    s_nop 0
    v_mfma_f32_16x16x32_bf16 v[60:63], v[20:23], v[108:111], v[60:63]
    v_perm_b32 v16, v46, v46, v26
    v_perm_b32 v17, v46, v46, v27
    v_perm_b32 v18, v46, v46, v28
    v_perm_b32 v19, v46, v46, v29
    s_waitcnt vmcnt(27)
    s_nop 0
    v_mfma_f32_16x16x32_bf16 v[60:63], v[16:19], v[112:115], v[60:63]
    v_perm_b32 v20, v46, v46, v30
    v_perm_b32 v21, v46, v46, v31
    v_perm_b32 v22, v46, v46, v32
    v_perm_b32 v23, v46, v46, v33
    s_waitcnt vmcnt(26)
    s_nop 0
    v_mfma_f32_16x16x32_bf16 v[60:63], v[20:23], v[116:119], v[60:63]
    v_perm_b32 v16, v47, v47, v26
    v_perm_b32 v17, v47, v47, v27
    v_perm_b32 v18, v47, v47, v28
    v_perm_b32 v19, v47, v47, v29
    s_waitcnt vmcnt(25)
    s_nop 0
    v_mfma_f32_16x16x32_bf16 v[60:63], v[16:19], v[120:123], v[60:63]
    v_perm_b32 v20, v47, v47, v30
    v_perm_b32 v21, v47, v47, v31
    v_perm_b32 v22, v47, v47, v32
    v_perm_b32 v23, v47, v47, v33
    s_waitcnt vmcnt(24)
    s_nop 0
    v_mfma_f32_16x16x32_bf16 v[60:63], v[20:23], v[124:127], v[60:63]
    v_perm_b32 v16, v48, v48, v26
    v_perm_b32 v17, v48, v48, v27
    v_perm_b32 v18, v48, v48, v28
    v_perm_b32 v19, v48, v48, v29
    s_waitcnt vmcnt(23)
    s_nop 0
    v_mfma_f32_16x16x32_bf16 v[60:63], v[16:19], v[128:131], v[60:63]
    v_perm_b32 v20, v48, v48, v30
    v_perm_b32 v21, v48, v48, v31
    v_perm_b32 v22, v48, v48, v32
    v_perm_b32 v23, v48, v48, v33
    s_waitcnt vmcnt(22)
    s_nop 0
    v_mfma_f32_16x16x32_bf16 v[60:63], v[20:23], v[132:135], v[60:63]
    v_perm_b32 v16, v49, v49, v26
    v_perm_b32 v17, v49, v49, v27
    v_perm_b32 v18, v49, v49, v28
    v_perm_b32 v19, v49, v49, v29
    s_waitcnt vmcnt(21)
    s_nop 0
    v_mfma_f32_16x16x32_bf16 v[60:63], v[16:19], v[136:139], v[60:63]
    v_perm_b32 v20, v49, v49, v30
    v_perm_b32 v21, v49, v49, v31
    v_perm_b32 v22, v49, v49, v32
    v_perm_b32 v23, v49, v49, v33
    s_waitcnt vmcnt(20)
    s_nop 0
    v_mfma_f32_16x16x32_bf16 v[60:63], v[20:23], v[140:143], v[60:63]
    v_perm_b32 v16, v50, v50, v26
    v_perm_b32 v17, v50, v50, v27
    v_perm_b32 v18, v50, v50, v28
    v_perm_b32 v19, v50, v50, v29
    s_waitcnt vmcnt(19)
    s_nop 0
    v_mfma_f32_16x16x32_bf16 v[60:63], v[16:19], v[144:147], v[60:63]
    v_perm_b32 v20, v50, v50, v30
    v_perm_b32 v21, v50, v50, v31
    v_perm_b32 v22, v50, v50, v32
    v_perm_b32 v23, v50, v50, v33
    s_waitcnt vmcnt(18)
    s_nop 0
    v_mfma_f32_16x16x32_bf16 v[60:63], v[20:23], v[148:151], v[60:63]
    v_perm_b32 v16, v51, v51, v26
    v_perm_b32 v17, v51, v51, v27
    v_perm_b32 v18, v51, v51, v28
    v_perm_b32 v19, v51, v51, v29
    s_waitcnt vmcnt(17)
    s_nop 0
    v_mfma_f32_16x16x32_bf16 v[60:63], v[16:19], v[152:155], v[60:63]
    v_perm_b32 v20, v51, v51, v30
    v_perm_b32 v21, v51, v51, v31
    v_perm_b32 v22, v51, v51, v32
    v_perm_b32 v23, v51, v51, v33
    s_waitcnt vmcnt(16)
    s_nop 0
    v_mfma_f32_16x16x32_bf16 v[60:63], v[20:23], v[156:159], v[60:63]
    v_perm_b32 v16, v52, v52, v26
    v_perm_b32 v17, v52, v52, v27
    v_perm_b32 v18, v52, v52, v28
    v_perm_b32 v19, v52, v52, v29
    s_waitcnt vmcnt(15)
    s_nop 0
    v_mfma_f32_16x16x32_bf16 v[60:63], v[16:19], v[160:163], v[60:63]
    v_perm_b32 v20, v52, v52, v30
    v_perm_b32 v21, v52, v52, v31
    v_perm_b32 v22, v52, v52, v32
    v_perm_b32 v23, v52, v52, v33
    s_waitcnt vmcnt(14)
    s_nop 0
    v_mfma_f32_16x16x32_bf16 v[60:63], v[20:23], v[164:167], v[60:63]
    v_perm_b32 v16, v53, v53, v26
    v_perm_b32 v17, v53, v53, v27
    v_perm_b32 v18, v53, v53, v28
    v_perm_b32 v19, v53, v53, v29
    s_waitcnt vmcnt(13)
    s_nop 0
    v_mfma_f32_16x16x32_bf16 v[60:63], v[16:19], v[168:171], v[60:63]
    v_perm_b32 v20, v53, v53, v30
    v_perm_b32 v21, v53, v53, v31
    v_perm_b32 v22, v53, v53, v32
    v_perm_b32 v23, v53, v53, v33
    s_waitcnt vmcnt(12)
    s_nop 0
    v_mfma_f32_16x16x32_bf16 v[60:63], v[20:23], v[172:175], v[60:63]
    v_perm_b32 v16, v54, v54, v26
    v_perm_b32 v17, v54, v54, v27
    v_perm_b32 v18, v54, v54, v28
    v_perm_b32 v19, v54, v54, v29
    s_waitcnt vmcnt(11)
    s_nop 0
    v_mfma_f32_16x16x32_bf16 v[60:63], v[16:19], v[176:179], v[60:63]
    v_perm_b32 v20, v54, v54, v30
    v_perm_b32 v21, v54, v54, v31
    v_perm_b32 v22, v54, v54, v32
    v_perm_b32 v23, v54, v54, v33
    s_waitcnt vmcnt(10)
    s_nop 0
    v_mfma_f32_16x16x32_bf16 v[60:63], v[20:23], v[180:183], v[60:63]
    v_perm_b32 v16, v55, v55, v26
    v_perm_b32 v17, v55, v55, v27
    v_perm_b32 v18, v55, v55, v28
    v_perm_b32 v19, v55, v55, v29
    s_waitcnt vmcnt(9)
    s_nop 0
    v_mfma_f32_16x16x32_bf16 v[60:63], v[16:19], v[184:187], v[60:63]
    v_perm_b32 v20, v55, v55, v30
    v_perm_b32 v21, v55, v55, v31
    v_perm_b32 v22, v55, v55, v32
    v_perm_b32 v23, v55, v55, v33
    s_waitcnt vmcnt(8)
    s_nop 0
    v_mfma_f32_16x16x32_bf16 v[60:63], v[20:23], v[188:191], v[60:63]
    v_perm_b32 v16, v56, v56, v26
    v_perm_b32 v17, v56, v56, v27
    v_perm_b32 v18, v56, v56, v28
    v_perm_b32 v19, v56, v56, v29
    s_waitcnt vmcnt(7)
    s_nop 0
    v_mfma_f32_16x16x32_bf16 v[60:63], v[16:19], v[192:195], v[60:63]
    v_perm_b32 v20, v56, v56, v30
    v_perm_b32 v21, v56, v56, v31
    v_perm_b32 v22, v56, v56, v32
    v_perm_b32 v23, v56, v56, v33
    s_waitcnt vmcnt(6)
    s_nop 0
    v_mfma_f32_16x16x32_bf16 v[60:63], v[20:23], v[196:199], v[60:63]
    v_perm_b32 v16, v57, v57, v26
    v_perm_b32 v17, v57, v57, v27
    v_perm_b32 v18, v57, v57, v28
    v_perm_b32 v19, v57, v57, v29
    s_waitcnt vmcnt(5)
    s_nop 0
    v_mfma_f32_16x16x32_bf16 v[60:63], v[16:19], v[200:203], v[60:63]
    v_perm_b32 v20, v57, v57, v30
    v_perm_b32 v21, v57, v57, v31
    v_perm_b32 v22, v57, v57, v32
    v_perm_b32 v23, v57, v57, v33
    s_waitcnt vmcnt(4)
    s_nop 0
    v_mfma_f32_16x16x32_bf16 v[60:63], v[20:23], v[204:207], v[60:63]
    v_perm_b32 v16, v58, v58, v26
    v_perm_b32 v17, v58, v58, v27
    v_perm_b32 v18, v58, v58, v28
    v_perm_b32 v19, v58, v58, v29
    s_waitcnt vmcnt(3)
    s_nop 0
    v_mfma_f32_16x16x32_bf16 v[60:63], v[16:19], v[208:211], v[60:63]
    v_perm_b32 v20, v58, v58, v30
    v_perm_b32 v21, v58, v58, v31
    v_perm_b32 v22, v58, v58, v32
    v_perm_b32 v23, v58, v58, v33
    s_waitcnt vmcnt(2)
    s_nop 0
    v_mfma_f32_16x16x32_bf16 v[60:63], v[20:23], v[212:215], v[60:63]
    v_perm_b32 v16, v59, v59, v26
    v_perm_b32 v17, v59, v59, v27
    v_perm_b32 v18, v59, v59, v28
    v_perm_b32 v19, v59, v59, v29
    s_waitcnt vmcnt(1)
    s_nop 0
    v_mfma_f32_16x16x32_bf16 v[60:63], v[16:19], v[216:219], v[60:63]
    v_perm_b32 v20, v59, v59, v30
    v_perm_b32 v21, v59, v59, v31
    v_perm_b32 v22, v59, v59, v32
    v_perm_b32 v23, v59, v59, v33
    s_waitcnt vmcnt(0)
    s_nop 0
    v_mfma_f32_16x16x32_bf16 v[60:63], v[20:23], v[220:223], v[60:63]
    s_nop 7
    v_and_or_b32 v60, v60, s14, v12
    v_and_or_b32 v61, v61, s14, v13
    v_and_or_b32 v62, v62, s14, v14
    v_and_or_b32 v63, v63, s14, v15
    buffer_store_dwordx4 v[60:63], v10, s[44:47], s10 offen sc1
L_pst:
    s_branch L_qg
L_noP:
    s_barrier
    v_and_b32 v26, 1, v1
    v_lshlrev_b32 v26, 4, v26
    v_mov_b32 v27, 0xffff
    v_lshlrev_b32 v27, v26, v27
    v_bfe_u32 v26, v1, 1, 2
    v_cmp_eq_u32 vcc, 0, v26
    s_nop 1
    v_cndmask_b32 v4, 0, v27, vcc
    v_cmp_eq_u32 vcc, 1, v26
    s_nop 1
    v_cndmask_b32 v5, 0, v27, vcc
    v_cmp_eq_u32 vcc, 2, v26
    s_nop 1
    v_cndmask_b32 v6, 0, v27, vcc
    v_cmp_eq_u32 vcc, 3, v26
    s_nop 1
    v_cndmask_b32 v7, 0, v27, vcc
    s_mov_b32 s44, s34
    s_mov_b32 s45, s35
    s_mov_b32 s46, 4194304
    s_mov_b32 s47, 0x20000
    s_mov_b32 s13, 0xffff0000
    s_waitcnt lgkmcnt(0)
    s_add_u32 s9, s9, 0x11111111
L_qg:
    v_and_b32 v10, 1, v1
    v_lshlrev_b32 v10, 4, v10
    v_bfe_u32 v12, s9, v10, 4
    v_add_u32 v13, 4, v10
    v_bfe_u32 v13, s9, v13, 4
    v_add_u32 v14, 8, v10
    v_bfe_u32 v14, s9, v14, 4
    v_add_u32 v15, 12, v10
    v_bfe_u32 v15, s9, v15, 4
    s_mul_i32 s11, s4, 768
    s_add_u32 s58, s11, 4096
    s_add_u32 s59, s58, 61440
    s_add_u32 s60, s58, 122880
    s_add_u32 s61, s58, 184320
    v_lshlrev_b32 v16, 4, v1
    v_add_u32 v17, 12288, v16
    v_add_u32 v18, 30720, v16
    v_add_u32 v19, 43008, v16
    s_mov_b32 s11, 65536
    s_mov_b32 exec_lo, -1
    s_mov_b32 exec_hi, 0xffff
    s_waitcnt vmcnt(0)
L_qpoll:
    buffer_load_dwordx4 v[64:67], v16, s[44:47], s58 offen sc1
    buffer_load_dwordx4 v[68:71], v16, s[44:47], s59 offen sc1
    buffer_load_dwordx4 v[72:75], v16, s[44:47], s60 offen sc1
    buffer_load_dwordx4 v[76:79], v16, s[44:47], s61 offen sc1
    buffer_load_dwordx4 v[80:83], v17, s[44:47], s58 offen sc1
    buffer_load_dwordx4 v[84:87], v17, s[44:47], s59 offen sc1
    buffer_load_dwordx4 v[88:91], v17, s[44:47], s60 offen sc1
    buffer_load_dwordx4 v[92:95], v17, s[44:47], s61 offen sc1
    buffer_load_dwordx4 v[96:99], v18, s[44:47], s58 offen sc1
    buffer_load_dwordx4 v[100:103], v18, s[44:47], s59 offen sc1
    buffer_load_dwordx4 v[104:107], v18, s[44:47], s60 offen sc1
    buffer_load_dwordx4 v[108:111], v18, s[44:47], s61 offen sc1
    buffer_load_dwordx4 v[112:115], v19, s[44:47], s58 offen sc1
    buffer_load_dwordx4 v[116:119], v19, s[44:47], s59 offen sc1
    buffer_load_dwordx4 v[120:123], v19, s[44:47], s60 offen sc1
    buffer_load_dwordx4 v[124:127], v19, s[44:47], s61 offen sc1
    v_mov_b32 v11, 0
    s_waitcnt vmcnt(12)
    v_xor_b32 v64, v64, v12
    v_xor_b32 v65, v65, v13
    v_xor_b32 v66, v66, v14
    v_xor_b32 v67, v67, v15
    v_xor_b32 v68, v68, v12
    v_xor_b32 v69, v69, v13
    v_xor_b32 v70, v70, v14
    v_xor_b32 v71, v71, v15
    v_xor_b32 v72, v72, v12
    v_xor_b32 v73, v73, v13
    v_xor_b32 v74, v74, v14
    v_xor_b32 v75, v75, v15
    v_xor_b32 v76, v76, v12
    v_xor_b32 v77, v77, v13
    v_xor_b32 v78, v78, v14
    v_xor_b32 v79, v79, v15
    v_or3_b32 v11, v11, v64, v65
    v_or3_b32 v11, v11, v66, v67
    v_or3_b32 v11, v11, v68, v69
    v_or3_b32 v11, v11, v70, v71
    v_or3_b32 v11, v11, v72, v73
    v_or3_b32 v11, v11, v74, v75
    v_or3_b32 v11, v11, v76, v77
    v_or3_b32 v11, v11, v78, v79
    s_waitcnt vmcnt(8)
    v_xor_b32 v80, v80, v12
    v_xor_b32 v81, v81, v13
    v_xor_b32 v82, v82, v14
    v_xor_b32 v83, v83, v15
    v_xor_b32 v84, v84, v12
    v_xor_b32 v85, v85, v13
    v_xor_b32 v86, v86, v14
    v_xor_b32 v87, v87, v15
    v_xor_b32 v88, v88, v12
    v_xor_b32 v89, v89, v13
    v_xor_b32 v90, v90, v14
    v_xor_b32 v91, v91, v15
    v_xor_b32 v92, v92, v12
    v_xor_b32 v93, v93, v13
    v_xor_b32 v94, v94, v14
    v_xor_b32 v95, v95, v15
    v_or3_b32 v11, v11, v80, v81
    v_or3_b32 v11, v11, v82, v83
    v_or3_b32 v11, v11, v84, v85
    v_or3_b32 v11, v11, v86, v87
    v_or3_b32 v11, v11, v88, v89
    v_or3_b32 v11, v11, v90, v91
    v_or3_b32 v11, v11, v92, v93
    v_or3_b32 v11, v11, v94, v95
    s_waitcnt vmcnt(4)
    v_xor_b32 v96, v96, v12
    v_xor_b32 v97, v97, v13
    v_xor_b32 v98, v98, v14
    v_xor_b32 v99, v99, v15
    v_xor_b32 v100, v100, v12
    v_xor_b32 v101, v101, v13
    v_xor_b32 v102, v102, v14
    v_xor_b32 v103, v103, v15
    v_xor_b32 v104, v104, v12
    v_xor_b32 v105, v105, v13
    v_xor_b32 v106, v106, v14
    v_xor_b32 v107, v107, v15
    v_xor_b32 v108, v108, v12
    v_xor_b32 v109, v109, v13
    v_xor_b32 v110, v110, v14
    v_xor_b32 v111, v111, v15
    v_or3_b32 v11, v11, v96, v97
    v_or3_b32 v11, v11, v98, v99
    v_or3_b32 v11, v11, v100, v101
    v_or3_b32 v11, v11, v102, v103
    v_or3_b32 v11, v11, v104, v105
    v_or3_b32 v11, v11, v106, v107
    v_or3_b32 v11, v11, v108, v109
    v_or3_b32 v11, v11, v110, v111
    s_waitcnt vmcnt(0)
    v_xor_b32 v112, v112, v12
    v_xor_b32 v113, v113, v13
    v_xor_b32 v114, v114, v14
    v_xor_b32 v115, v115, v15
    v_xor_b32 v116, v116, v12
    v_xor_b32 v117, v117, v13
    v_xor_b32 v118, v118, v14
    v_xor_b32 v119, v119, v15
    v_xor_b32 v120, v120, v12
    v_xor_b32 v121, v121, v13
    v_xor_b32 v122, v122, v14
    v_xor_b32 v123, v123, v15
    v_xor_b32 v124, v124, v12
    v_xor_b32 v125, v125, v13
    v_xor_b32 v126, v126, v14
    v_xor_b32 v127, v127, v15
    v_or3_b32 v11, v11, v112, v113
    v_or3_b32 v11, v11, v114, v115
    v_or3_b32 v11, v11, v116, v117
    v_or3_b32 v11, v11, v118, v119
    v_or3_b32 v11, v11, v120, v121
    v_or3_b32 v11, v11, v122, v123
    v_or3_b32 v11, v11, v124, v125
    v_or3_b32 v11, v11, v126, v127
    v_and_b32 v11, 15, v11
    v_cmp_ne_u32 vcc, 0, v11
    s_cbranch_vccz L_qok
    s_sub_u32 s11, s11, 1
    s_cmp_lg_u32 s11, 0
    s_cbranch_scc1 L_qpoll
L_qok:
    v_lshlrev_b32 v10, 3, v1
    v_pk_add_f32 v[64:65], v[64:65], v[68:69]
    v_pk_add_f32 v[72:73], v[72:73], v[76:77]
    v_pk_add_f32 v[66:67], v[66:67], v[70:71]
    v_pk_add_f32 v[74:75], v[74:75], v[78:79]
    v_pk_add_f32 v[64:65], v[64:65], v[72:73]
    v_pk_add_f32 v[66:67], v[66:67], v[74:75]
    v_cvt_pk_bf16_f32 v64, v64, v65
    v_cvt_pk_bf16_f32 v65, v66, v67
    ds_write_b64 v10, v[64:65] offset:0
    v_pk_add_f32 v[80:81], v[80:81], v[84:85]
    v_pk_add_f32 v[88:89], v[88:89], v[92:93]
    v_pk_add_f32 v[82:83], v[82:83], v[86:87]
    v_pk_add_f32 v[90:91], v[90:91], v[94:95]
    v_pk_add_f32 v[80:81], v[80:81], v[88:89]
    v_pk_add_f32 v[82:83], v[82:83], v[90:91]
    v_cvt_pk_bf16_f32 v80, v80, v81
    v_cvt_pk_bf16_f32 v81, v82, v83
    ds_write_b64 v10, v[80:81] offset:384
    v_pk_add_f32 v[96:97], v[96:97], v[100:101]
    v_pk_add_f32 v[104:105], v[104:105], v[108:109]
    v_pk_add_f32 v[98:99], v[98:99], v[102:103]
    v_pk_add_f32 v[106:107], v[106:107], v[110:111]
    v_pk_add_f32 v[96:97], v[96:97], v[104:105]
    v_pk_add_f32 v[98:99], v[98:99], v[106:107]
    v_cvt_pk_bf16_f32 v96, v96, v97
    v_cvt_pk_bf16_f32 v97, v98, v99
    ds_write_b64 v10, v[96:97] offset:768
    v_pk_add_f32 v[112:113], v[112:113], v[116:117]
    v_pk_add_f32 v[120:121], v[120:121], v[124:125]
    v_pk_add_f32 v[114:115], v[114:115], v[118:119]
    v_pk_add_f32 v[122:123], v[122:123], v[126:127]
    v_pk_add_f32 v[112:113], v[112:113], v[120:121]
    v_pk_add_f32 v[114:115], v[114:115], v[122:123]
    v_cvt_pk_bf16_f32 v112, v112, v113
    v_cvt_pk_bf16_f32 v113, v114, v115
    ds_write_b64 v10, v[112:113] offset:1152
    v_mov_b32 v16, 4
    v_mov_b32 v17, s9
    s_mov_b64 exec, 1
    ds_write_b64 v10, v[16:17] offset:1824
    s_mov_b64 exec, -1
    s_setprio 0
    s_mov_b32 s15, 0x3fb8aa3b
    s_mov_b32 s14, 0xffffff00
    v_and_b32 v9, 3, v1
    v_lshlrev_b32 v12, 3, v9
    v_bfe_u32 v12, s9, v12, 8
    s_branch L_merger
L_h123:
    s_sub_u32 s8, s3, 1
    v_and_b32 v26, 1, v1
    v_lshlrev_b32 v26, 4, v26
    v_mov_b32 v27, 0xffff
    v_lshlrev_b32 v27, v26, v27
    v_bfe_u32 v26, v1, 1, 2
    v_cmp_eq_u32 vcc, 0, v26
    s_nop 1
    v_cndmask_b32 v4, 0, v27, vcc
    v_cmp_eq_u32 vcc, 1, v26
    s_nop 1
    v_cndmask_b32 v5, 0, v27, vcc
    v_cmp_eq_u32 vcc, 2, v26
    s_nop 1
    v_cndmask_b32 v6, 0, v27, vcc
    v_cmp_eq_u32 vcc, 3, v26
    s_nop 1
    v_cndmask_b32 v7, 0, v27, vcc
    s_mov_b32 s44, s34
    s_mov_b32 s45, s35
    s_mov_b32 s46, 4194304
    s_mov_b32 s47, 0x20000
    s_mov_b32 s52, 1
    s_cmp_ge_u32 s7, 5
    s_cselect_b32 s10, 16, 0
    s_cselect_b32 s11, 5, 0
    s_add_u32 s53, s4, s10
    s_sub_u32 s54, s7, s11
    s_cmp_lt_u32 s7, 10
    s_cbranch_scc1 L_role
    s_mov_b32 s52, 2
    s_lshr_b32 s53, s4, 1
    s_xor_b32 s53, s53, 4
    s_and_b32 s10, s4, 1
    s_mul_i32 s11, s10, 3
    s_add_u32 s54, s7, s11
    s_sub_u32 s54, s54, 10
    s_add_u32 s10, s10, s7
    s_cmp_le_u32 s10, 12
    s_cbranch_scc1 L_role
    s_mov_b32 s52, 0
    s_cmp_eq_u32 s3, 3
    s_cbranch_scc1 L_role
    s_lshr_b32 s10, s2, 3
    s_lshl_b32 s10, s10, 2
    s_or_b32 s10, s10, s3
    s_cmp_eq_u32 s10, 126
    s_cbranch_scc1 L_role
    s_cmp_lg_u32 s2, 120
    s_cbranch_scc1 L_fin
    s_cmp_lg_u32 s3, 1
    s_cbranch_scc1 L_fin
L_role:
    s_mov_b32 s63, 4194304
    v_mov_b32 v2, 32
L_lw1:
    ds_read_b32 v26, v2 offset:1792
    s_waitcnt lgkmcnt(0)
    v_readfirstlane_b32 s10, v26
    s_cmp_ge_u32 s10, 4
    s_cbranch_scc1 L_lw1_d
    s_sub_u32 s63, s63, 1
    s_cmp_lg_u32 s63, 0
    s_cbranch_scc1 L_lw1
L_lw1_d:
    ds_read_b32 v26, v2 offset:1796
    s_waitcnt lgkmcnt(0)
    v_readfirstlane_b32 s9, v26
    s_mov_b32 s15, 0x3fb8aa3b
    s_mov_b32 s14, 0xffffff00
    v_and_b32 v9, 3, v1
    v_lshlrev_b32 v12, 3, v9
    v_bfe_u32 v12, s9, v12, 8
    s_and_b32 s88, s9, 0xfffff000
    s_and_b32 s90, s2, 7
    s_lshl_b32 s90, s90, 8
    s_add_u32 s90, s90, 507904
    s_lshr_b32 s10, s2, 3
    s_lshl_b32 s89, s10, 2
    s_add_u32 s89, s89, s90
    s_cmp_eq_u32 s10, 31
    s_cselect_b32 s94, 32, -1
    v_lshlrev_b32 v44, 2, v1
    s_mov_b32 s62, 1310720
    s_mov_b32 s86, 0x65432100
    s_cmp_lg_u32 s52, 0
    s_cbranch_scc1 L_hasrole
    s_cmp_eq_u32 s3, 1
    s_cbranch_scc1 L_bump
    s_cmp_eq_u32 s3, 3
    s_cbranch_scc1 L_noldr
    s_mov_b32 s63, 4194304
    v_mov_b32 v2, 64
    s_mov_b32 s94, 32
    s_mov_b64 exec, 1
L_ld:
    ds_read_b32 v45, v2 offset:1792
    ds_read_b32 v46, v2 offset:1800
    s_waitcnt lgkmcnt(0)
    v_readfirstlane_b32 s11, v45
    v_readfirstlane_b32 s10, v46
    s_cmp_ge_u32 s11, 424
    s_cbranch_scc1 L_fin
    s_sub_u32 s63, s63, 1
    s_cmp_eq_u32 s63, 0
    s_cbranch_scc1 L_fin
    s_add_u32 s10, s10, s11
    s_cmp_lt_i32 s10, s94
    s_cbranch_scc1 L_ld
    s_add_u32 s94, s94, 32
    v_mov_b32 v45, 1
    buffer_atomic_add v45, v44, s[44:47], s62 offen sc0
    s_add_u32 s62, s62, 8448
    s_cmp_ge_u32 s62, 1445888
    s_cselect_b32 s62, 1310720, s62
    s_waitcnt vmcnt(0)
    v_readfirstlane_b32 s10, v45
    s_and_b32 s10, s10, 7
    s_lshl_b32 s10, s10, 2
    s_lshr_b32 s10, s86, s10
    s_and_b32 s10, s10, 15
    s_or_b32 s10, s10, s88
    v_mov_b32 v45, s10
    buffer_store_dword v45, v44, s[44:47], s90 offen offset:128
    s_branch L_ld
L_noldr:
    s_cmp_eq_u32 s3, 3
    s_cbranch_scc1 L_ct1
    s_mov_b32 s63, 4194304
    v_mov_b32 v2, 64
L_lw2:
    ds_read_b32 v26, v2 offset:1792
    s_waitcnt lgkmcnt(0)
    v_readfirstlane_b32 s10, v26
    s_cmp_ge_u32 s10, 424
    s_cbranch_scc1 L_lw2_d
    s_sub_u32 s63, s63, 1
    s_cmp_lg_u32 s63, 0
    s_cbranch_scc1 L_lw2
L_lw2_d:
    s_branch L_cd1
L_ct1:
    s_mov_b32 s63, 262144
    v_mov_b32 v2, 64
    s_mov_b32 exec_lo, -1
    s_mov_b32 exec_hi, 1
L_cl1:
    ds_read_b32 v26, v2 offset:1792
    s_waitcnt lgkmcnt(0)
    v_readfirstlane_b32 s10, v26
    v_or_b32 v45, s88, v26
    s_cmp_ge_u32 s10, 424
    s_cbranch_scc1 L_cx1
    s_mov_b64 exec, 1
    buffer_store_dword v45, v44, s[44:47], s89 offen
    s_mov_b32 exec_lo, -1
    s_mov_b32 exec_hi, 1
    buffer_load_dword v46, v44, s[44:47], s90 offen sc1
    s_waitcnt vmcnt(0)
    v_xor_b32 v46, s88, v46
    v_cmp_gt_u32 vcc, 0x1000, v46
    s_nop 1
    v_cndmask_b32 v47, 0, v46, vcc
    v_cndmask_b32 v46, v26, v46, vcc
    v_readlane_b32 s91, v47, 32
    s_nop 0
    v_add_u32_dpp v46, v46, v46 quad_perm:[1,0,3,2] row_mask:0xf bank_mask:0xf
    s_nop 1
    v_add_u32_dpp v46, v46, v46 quad_perm:[2,3,0,1] row_mask:0xf bank_mask:0xf
    s_nop 1
    v_add_u32_dpp v46, v46, v46 row_half_mirror row_mask:0xf bank_mask:0xf
    s_nop 1
    v_add_u32_dpp v46, v46, v46 row_ror:8 row_mask:0xf bank_mask:0xf
    s_nop 0
    v_readlane_b32 s92, v46, 0
    v_readlane_b32 s93, v46, 16
    s_add_u32 s92, s92, s93
    s_lshr_b32 s92, s92, 5
    s_sub_u32 s93, s92, s10
    v_mov_b32 v46, s93
    ds_write_b32 v2, v46 offset:1800
    s_add_u32 s93, s93, s91
    v_mov_b32 v45, s93
    ds_write_b32 v2, v45 offset:1796
    s_sub_u32 s63, s63, 1
    s_cmp_lg_u32 s63, 0
    s_cbranch_scc1 L_cl1
L_cx1:
    s_mov_b64 exec, -1
L_cd1:
    s_branch L_fin
L_hasrole:
    s_cmp_eq_u32 s52, 1
    s_cselect_b32 s36, s24, s30
    s_cselect_b32 s37, s25, s31
    s_cselect_b32 s38, 4, 1
    s_mul_i32 s38, s38, 1966080
    s_mul_i32 s57, s53, 192
    s_lshl_b32 s55, s8, 6
    s_add_u32 s57, s57, s55
    s_mul_i32 s57, s57, 1280
    s_lshl_b32 s55, s54, 8
    s_add_u32 s57, s57, s55
    v_mul_u32_u24 v24, 20480, v3
    v_and_b32 v25, 15, v1
    v_lshl_add_u32 v24, v25, 4, v24
    v_lshlrev_b32 v10, 6, v3
    v_lshl_add_u32 v10, v9, 4, v10
    v_bfe_u32 v8, v1, 2, 2
    v_lshlrev_b32 v22, 4, v1
    v_lshrrev_b32 v20, 5, v1
    v_and_b32 v21, 16, v1
    v_lshl_add_u32 v21, v25, 5, v21
    v_lshl_add_u32 v21, v20, 9, v21
    s_lshl_b32 s10, s8, 10
    v_add_u32 v21, s10, v21
    v_lshl_add_u32 v23, v20, 11, v22
    v_mov_b32 v20, 20
    v_mov_b32 v27, 1
    s_lshl_b32 s60, s54, 9
    s_add_u32 s60, s60, 262144
    s_cmp_eq_u32 s3, 3
    s_cbranch_scc1 L_ct2
    s_mov_b32 s63, 4194304
    v_mov_b32 v2, 64
L_lw3:
    ds_read_b32 v26, v2 offset:1792
    s_waitcnt lgkmcnt(0)
    v_readfirstlane_b32 s10, v26
    s_cmp_ge_u32 s10, 352
    s_cbranch_scc1 L_lw3_d
    s_sub_u32 s63, s63, 1
    s_cmp_lg_u32 s63, 0
    s_cbranch_scc1 L_lw3
L_lw3_d:
    s_branch L_cd2
L_ct2:
    s_mov_b32 s63, 262144
    v_mov_b32 v2, 64
    s_mov_b32 exec_lo, -1
    s_mov_b32 exec_hi, 1
L_cl2:
    ds_read_b32 v26, v2 offset:1792
    s_waitcnt lgkmcnt(0)
    v_readfirstlane_b32 s10, v26
    v_or_b32 v45, s88, v26
    s_cmp_ge_u32 s10, 352
    s_cbranch_scc1 L_cx2
    s_mov_b64 exec, 1
    buffer_store_dword v45, v44, s[44:47], s89 offen
    s_mov_b32 exec_lo, -1
    s_mov_b32 exec_hi, 1
    buffer_load_dword v46, v44, s[44:47], s90 offen sc1
    s_waitcnt vmcnt(0)
    v_xor_b32 v46, s88, v46
    v_cmp_gt_u32 vcc, 0x1000, v46
    s_nop 1
    v_cndmask_b32 v47, 0, v46, vcc
    v_cndmask_b32 v46, v26, v46, vcc
    v_readlane_b32 s91, v47, 32
    s_nop 0
    v_add_u32_dpp v46, v46, v46 quad_perm:[1,0,3,2] row_mask:0xf bank_mask:0xf
    s_nop 1
    v_add_u32_dpp v46, v46, v46 quad_perm:[2,3,0,1] row_mask:0xf bank_mask:0xf
    s_nop 1
    v_add_u32_dpp v46, v46, v46 row_half_mirror row_mask:0xf bank_mask:0xf
    s_nop 1
    v_add_u32_dpp v46, v46, v46 row_ror:8 row_mask:0xf bank_mask:0xf
    s_nop 0
    v_readlane_b32 s92, v46, 0
    v_readlane_b32 s93, v46, 16
    s_add_u32 s92, s92, s93
    s_lshr_b32 s92, s92, 5
    s_sub_u32 s93, s92, s10
    v_mov_b32 v46, s93
    ds_write_b32 v2, v46 offset:1800
    s_add_u32 s93, s93, s91
    v_mov_b32 v45, s93
    ds_write_b32 v2, v45 offset:1796
    s_sub_u32 s63, s63, 1
    s_cmp_lg_u32 s63, 0
    s_cbranch_scc1 L_cl2
L_cx2:
    s_mov_b64 exec, -1
L_cd2:
    s_cmp_eq_u32 s52, 1
    s_cbranch_scc0 L_ffn
    s_mul_i32 s10, s53, 5120
    s_add_u32 s60, s60, s10
    v_mul_u32_u24 v11, 3072, v8
    v_add_u32 v10, v10, v11
    s_mul_i32 s59, s53, 12288
    s_lshl_b32 s10, s8, 8
    s_add_u32 s59, s59, s10
    s_add_u32 s59, s59, 524288
    s_lshl_b32 s58, s4, 10
    s_and_b32 s10, s53, 16
    s_add_u32 s58, s58, s10
    s_add_u32 s58, s58, 491520
    s_add_u32 s55, s58, 32
    v_lshlrev_b32 v11, 6, v25
    s_mov_b32 s11, 65536
L_mlpoll:
    buffer_load_dwordx4 v[28:31], v11, s[44:47], s58 offen sc1
    buffer_load_dwordx4 v[32:35], v11, s[44:47], s55 offen sc1
    s_waitcnt vmcnt(0)
    v_xor_b32 v30, s9, v30
    v_xor_b32 v34, s9, v34
    v_or_b32 v26, v30, v34
    v_cmp_ne_u32 vcc, 0, v26
    s_cbranch_vccz L_mlok
    s_sub_u32 s11, s11, 1
    s_cmp_lg_u32 s11, 0
    s_cbranch_scc1 L_mlpoll
L_mlok:
    v_max_f32_dpp v30, v28, v28 quad_perm:[1,0,3,2] row_mask:0xf bank_mask:0xf
    s_nop 1
    v_max_f32_dpp v30, v30, v30 quad_perm:[2,3,0,1] row_mask:0xf bank_mask:0xf
    s_nop 1
    v_max_f32_dpp v30, v30, v30 row_half_mirror row_mask:0xf bank_mask:0xf
    s_nop 1
    v_max_f32_dpp v30, v30, v30 row_ror:8 row_mask:0xf bank_mask:0xf
    v_sub_f32 v30, v28, v30
    v_mul_f32 v30, s15, v30
    v_exp_f32 v30, v30
    s_nop 0
    v_mul_f32 v31, v30, v29
    s_nop 1
    v_add_f32_dpp v31, v31, v31 quad_perm:[1,0,3,2] row_mask:0xf bank_mask:0xf
    s_nop 1
    v_add_f32_dpp v31, v31, v31 quad_perm:[2,3,0,1] row_mask:0xf bank_mask:0xf
    s_nop 1
    v_add_f32_dpp v31, v31, v31 row_half_mirror row_mask:0xf bank_mask:0xf
    s_nop 1
    v_add_f32_dpp v31, v31, v31 row_ror:8 row_mask:0xf bank_mask:0xf
    v_rcp_f32 v31, v31
    s_nop 0
    v_mul_f32 v14, v30, v31
    v_max_f32_dpp v30, v32, v32 quad_perm:[1,0,3,2] row_mask:0xf bank_mask:0xf
    s_nop 1
    v_max_f32_dpp v30, v30, v30 quad_perm:[2,3,0,1] row_mask:0xf bank_mask:0xf
    s_nop 1
    v_max_f32_dpp v30, v30, v30 row_half_mirror row_mask:0xf bank_mask:0xf
    s_nop 1
    v_max_f32_dpp v30, v30, v30 row_ror:8 row_mask:0xf bank_mask:0xf
    v_sub_f32 v30, v32, v30
    v_mul_f32 v30, s15, v30
    v_exp_f32 v30, v30
    s_nop 0
    v_mul_f32 v31, v30, v33
    s_nop 1
    v_add_f32_dpp v31, v31, v31 quad_perm:[1,0,3,2] row_mask:0xf bank_mask:0xf
    s_nop 1
    v_add_f32_dpp v31, v31, v31 quad_perm:[2,3,0,1] row_mask:0xf bank_mask:0xf
    s_nop 1
    v_add_f32_dpp v31, v31, v31 row_half_mirror row_mask:0xf bank_mask:0xf
    s_nop 1
    v_add_f32_dpp v31, v31, v31 row_ror:8 row_mask:0xf bank_mask:0xf
    v_rcp_f32 v31, v31
    s_nop 0
    v_mul_f32 v15, v30, v31
    s_mov_b32 s56, 0
L_batch:
    s_mov_b32 s11, 65536
L_opoll:
    buffer_load_dwordx4 v[28:31], v10, s[44:47], s59 offen offset:0 sc1
    buffer_load_dwordx4 v[32:35], v10, s[44:47], s59 offen offset:768 sc1
    buffer_load_dwordx4 v[36:39], v10, s[44:47], s59 offen offset:1536 sc1
    buffer_load_dwordx4 v[40:43], v10, s[44:47], s59 offen offset:2304 sc1
    s_waitcnt vmcnt(0)
    v_xor_b32 v28, v28, v12
    v_xor_b32 v32, v32, v12
    v_xor_b32 v36, v36, v12
    v_xor_b32 v40, v40, v12
    v_or3_b32 v26, v28, v32, v36
    v_or_b32 v26, v26, v40
    v_and_b32 v26, 0xff, v26
    v_cmp_ne_u32 vcc, 0, v26
    s_cbranch_vccz L_ook
    s_sub_u32 s11, s11, 1
    s_cmp_lg_u32 s11, 0
    s_cbranch_scc1 L_opoll
L_ook:
    v_mul_f32_dpp v64, v14, v28 quad_perm:[0,0,0,0] row_mask:0xf bank_mask:0xf
    v_mul_f32_dpp v65, v14, v29 quad_perm:[0,0,0,0] row_mask:0xf bank_mask:0xf
    v_mul_f32_dpp v66, v14, v30 quad_perm:[0,0,0,0] row_mask:0xf bank_mask:0xf
    v_mul_f32_dpp v67, v14, v31 quad_perm:[0,0,0,0] row_mask:0xf bank_mask:0xf
    v_fmac_f32_dpp v64, v14, v32 quad_perm:[1,1,1,1] row_mask:0xf bank_mask:0xf
    v_fmac_f32_dpp v65, v14, v33 quad_perm:[1,1,1,1] row_mask:0xf bank_mask:0xf
    v_fmac_f32_dpp v66, v14, v34 quad_perm:[1,1,1,1] row_mask:0xf bank_mask:0xf
    v_fmac_f32_dpp v67, v14, v35 quad_perm:[1,1,1,1] row_mask:0xf bank_mask:0xf
    v_fmac_f32_dpp v64, v14, v36 quad_perm:[2,2,2,2] row_mask:0xf bank_mask:0xf
    v_fmac_f32_dpp v65, v14, v37 quad_perm:[2,2,2,2] row_mask:0xf bank_mask:0xf
    v_fmac_f32_dpp v66, v14, v38 quad_perm:[2,2,2,2] row_mask:0xf bank_mask:0xf
    v_fmac_f32_dpp v67, v14, v39 quad_perm:[2,2,2,2] row_mask:0xf bank_mask:0xf
    v_fmac_f32_dpp v64, v14, v40 quad_perm:[3,3,3,3] row_mask:0xf bank_mask:0xf
    v_fmac_f32_dpp v65, v14, v41 quad_perm:[3,3,3,3] row_mask:0xf bank_mask:0xf
    v_fmac_f32_dpp v66, v14, v42 quad_perm:[3,3,3,3] row_mask:0xf bank_mask:0xf
    v_fmac_f32_dpp v67, v14, v43 quad_perm:[3,3,3,3] row_mask:0xf bank_mask:0xf
    v_add_f32_dpp v64, v64, v64 row_ror:4 row_mask:0xf bank_mask:0xf
    v_add_f32_dpp v65, v65, v65 row_ror:4 row_mask:0xf bank_mask:0xf
    v_add_f32_dpp v66, v66, v66 row_ror:4 row_mask:0xf bank_mask:0xf
    v_add_f32_dpp v67, v67, v67 row_ror:4 row_mask:0xf bank_mask:0xf
    s_cmp_lg_u32 s56, 0
    s_cbranch_scc1 L_b1
    v_add_f32_dpp v68, v64, v64 row_ror:8 row_mask:0xf bank_mask:0xf
    v_add_f32_dpp v69, v65, v65 row_ror:8 row_mask:0xf bank_mask:0xf
    v_add_f32_dpp v70, v66, v66 row_ror:8 row_mask:0xf bank_mask:0xf
    v_add_f32_dpp v71, v67, v67 row_ror:8 row_mask:0xf bank_mask:0xf
    s_mov_b32 s56, 1
    s_add_u32 s59, s59, 393216
    v_mov_b32 v14, v15
L_late:
    s_cmp_eq_u32 s3, 3
    s_cbranch_scc1 L_ct3
    s_mov_b32 s63, 4194304
    v_mov_b32 v2, 64
L_lw4:
    ds_read_b32 v26, v2 offset:1792
    s_waitcnt lgkmcnt(0)
    v_readfirstlane_b32 s10, v26
    s_cmp_ge_u32 s10, 424
    s_cbranch_scc1 L_lw4_d
    s_sub_u32 s63, s63, 1
    s_cmp_lg_u32 s63, 0
    s_cbranch_scc1 L_lw4
L_lw4_d:
    s_branch L_cd3
L_ct3:
    s_mov_b32 s63, 262144
    v_mov_b32 v2, 64
    s_mov_b32 exec_lo, -1
    s_mov_b32 exec_hi, 1
L_cl3:
    ds_read_b32 v26, v2 offset:1792
    s_waitcnt lgkmcnt(0)
    v_readfirstlane_b32 s10, v26
    v_or_b32 v45, s88, v26
    s_cmp_ge_u32 s10, 424
    s_cbranch_scc1 L_cx3
    s_mov_b64 exec, 1
    buffer_store_dword v45, v44, s[44:47], s89 offen
    s_mov_b32 exec_lo, -1
    s_mov_b32 exec_hi, 1
    buffer_load_dword v46, v44, s[44:47], s90 offen sc1
    s_waitcnt vmcnt(0)
    v_xor_b32 v46, s88, v46
    v_cmp_gt_u32 vcc, 0x1000, v46
    s_nop 1
    v_cndmask_b32 v47, 0, v46, vcc
    v_cndmask_b32 v46, v26, v46, vcc
    v_readlane_b32 s91, v47, 32
    s_nop 0
    v_add_u32_dpp v46, v46, v46 quad_perm:[1,0,3,2] row_mask:0xf bank_mask:0xf
    s_nop 1
    v_add_u32_dpp v46, v46, v46 quad_perm:[2,3,0,1] row_mask:0xf bank_mask:0xf
    s_nop 1
    v_add_u32_dpp v46, v46, v46 row_half_mirror row_mask:0xf bank_mask:0xf
    s_nop 1
    v_add_u32_dpp v46, v46, v46 row_ror:8 row_mask:0xf bank_mask:0xf
    s_nop 0
    v_readlane_b32 s92, v46, 0
    v_readlane_b32 s93, v46, 16
    s_add_u32 s92, s92, s93
    s_lshr_b32 s92, s92, 5
    s_sub_u32 s93, s92, s10
    v_mov_b32 v46, s93
    ds_write_b32 v2, v46 offset:1800
    s_add_u32 s93, s93, s91
    v_mov_b32 v45, s93
    ds_write_b32 v2, v45 offset:1796
    s_sub_u32 s63, s63, 1
    s_cmp_lg_u32 s63, 0
    s_cbranch_scc1 L_cl3
L_cx3:
    s_mov_b64 exec, -1
L_cd3:
    s_mov_b32 s63, 4194304
    v_mov_b32 v2, 28
L_lw5:
    ds_read_b32 v26, v2 offset:1792
    s_waitcnt lgkmcnt(0)
    v_readfirstlane_b32 s10, v26
    s_cmp_ge_u32 s10, 2
    s_cbranch_scc1 L_lw5_d
    s_sub_u32 s63, s63, 1
    s_cmp_lg_u32 s63, 0
    s_cbranch_scc1 L_lw5
L_lw5_d:
    buffer_load_dwordx4 v[96:99], v24, s[36:39], s57 offen nt
    s_add_u32 s57, s57, 1280
    buffer_load_dwordx4 v[100:103], v24, s[36:39], s57 offen nt
    s_add_u32 s57, s57, 1280
    buffer_load_dwordx4 v[104:107], v24, s[36:39], s57 offen nt
    s_add_u32 s57, s57, 1280
    buffer_load_dwordx4 v[108:111], v24, s[36:39], s57 offen nt
    s_add_u32 s57, s57, 1280
    buffer_load_dwordx4 v[112:115], v24, s[36:39], s57 offen nt
    s_add_u32 s57, s57, 1280
    buffer_load_dwordx4 v[116:119], v24, s[36:39], s57 offen nt
    s_add_u32 s57, s57, 1280
    buffer_load_dwordx4 v[120:123], v24, s[36:39], s57 offen nt
    s_add_u32 s57, s57, 1280
    buffer_load_dwordx4 v[124:127], v24, s[36:39], s57 offen nt
    s_add_u32 s57, s57, 1280
    buffer_load_dwordx4 v[128:131], v24, s[36:39], s57 offen nt
    s_add_u32 s57, s57, 1280
    s_waitcnt vmcnt(8)
    buffer_load_dwordx4 v[132:135], v24, s[36:39], s57 offen nt
    s_add_u32 s57, s57, 1280
    s_waitcnt vmcnt(8)
    buffer_load_dwordx4 v[136:139], v24, s[36:39], s57 offen nt
    s_add_u32 s57, s57, 1280
    s_waitcnt vmcnt(8)
    buffer_load_dwordx4 v[140:143], v24, s[36:39], s57 offen nt
    s_add_u32 s57, s57, 1280
    s_waitcnt vmcnt(8)
    buffer_load_dwordx4 v[144:147], v24, s[36:39], s57 offen nt
    s_add_u32 s57, s57, 1280
    s_waitcnt vmcnt(8)
    buffer_load_dwordx4 v[148:151], v24, s[36:39], s57 offen nt
    s_add_u32 s57, s57, 1280
    s_waitcnt vmcnt(8)
    buffer_load_dwordx4 v[152:155], v24, s[36:39], s57 offen nt
    s_add_u32 s57, s57, 1280
    s_waitcnt vmcnt(8)
    buffer_load_dwordx4 v[156:159], v24, s[36:39], s57 offen nt
    s_cmp_eq_u32 s52, 2
    s_cbranch_scc0 L_notffn
    s_waitcnt vmcnt(0)
    s_branch L_gemv
L_notffn:
    s_mov_b32 s63, 4194304
    v_mov_b32 v2, 16
L_lw6:
    ds_read_b32 v26, v2 offset:1792
    s_waitcnt lgkmcnt(0)
    v_readfirstlane_b32 s10, v26
    s_cmp_ge_u32 s10, 5
    s_cbranch_scc1 L_lw6_d
    s_sub_u32 s63, s63, 1
    s_cmp_lg_u32 s63, 0
    s_cbranch_scc1 L_lw6
L_lw6_d:
    s_branch L_batch
L_b1:
    v_add_f32_dpp v68, v64, v64 row_ror:8 row_mask:0xf bank_mask:0xc
    v_add_f32_dpp v69, v65, v65 row_ror:8 row_mask:0xf bank_mask:0xc
    v_add_f32_dpp v70, v66, v66 row_ror:8 row_mask:0xf bank_mask:0xc
    v_add_f32_dpp v71, v67, v67 row_ror:8 row_mask:0xf bank_mask:0xc
L_gemv:
    v_cvt_pk_bf16_f32 v68, v68, v68
    v_cvt_pk_bf16_f32 v69, v69, v69
    v_cvt_pk_bf16_f32 v70, v70, v70
    v_cvt_pk_bf16_f32 v71, v71, v71
    v_and_b32_dpp v72, v68, v4 quad_perm:[0,0,0,0] row_mask:0xf bank_mask:0xf
    v_and_b32_dpp v73, v68, v5 quad_perm:[0,0,0,0] row_mask:0xf bank_mask:0xf
    v_and_b32_dpp v74, v68, v6 quad_perm:[0,0,0,0] row_mask:0xf bank_mask:0xf
    v_and_b32_dpp v75, v68, v7 quad_perm:[0,0,0,0] row_mask:0xf bank_mask:0xf
    v_and_b32_dpp v76, v69, v4 quad_perm:[0,0,0,0] row_mask:0xf bank_mask:0xf
    v_and_b32_dpp v77, v69, v5 quad_perm:[0,0,0,0] row_mask:0xf bank_mask:0xf
    v_mfma_f32_16x16x32_bf16 v[60:63], v[72:75], v[96:99], 0
    v_and_b32_dpp v78, v69, v6 quad_perm:[0,0,0,0] row_mask:0xf bank_mask:0xf
    v_and_b32_dpp v79, v69, v7 quad_perm:[0,0,0,0] row_mask:0xf bank_mask:0xf
    v_and_b32_dpp v72, v70, v4 quad_perm:[0,0,0,0] row_mask:0xf bank_mask:0xf
    v_and_b32_dpp v73, v70, v5 quad_perm:[0,0,0,0] row_mask:0xf bank_mask:0xf
    v_mfma_f32_16x16x32_bf16 v[60:63], v[76:79], v[100:103], v[60:63]
    v_and_b32_dpp v74, v70, v6 quad_perm:[0,0,0,0] row_mask:0xf bank_mask:0xf
    v_and_b32_dpp v75, v70, v7 quad_perm:[0,0,0,0] row_mask:0xf bank_mask:0xf
    v_and_b32_dpp v76, v71, v4 quad_perm:[0,0,0,0] row_mask:0xf bank_mask:0xf
    v_and_b32_dpp v77, v71, v5 quad_perm:[0,0,0,0] row_mask:0xf bank_mask:0xf
    v_mfma_f32_16x16x32_bf16 v[60:63], v[72:75], v[104:107], v[60:63]
    v_and_b32_dpp v78, v71, v6 quad_perm:[0,0,0,0] row_mask:0xf bank_mask:0xf
    v_and_b32_dpp v79, v71, v7 quad_perm:[0,0,0,0] row_mask:0xf bank_mask:0xf
    v_and_b32_dpp v72, v68, v4 quad_perm:[1,1,1,1] row_mask:0xf bank_mask:0xf
    v_and_b32_dpp v73, v68, v5 quad_perm:[1,1,1,1] row_mask:0xf bank_mask:0xf
    v_mfma_f32_16x16x32_bf16 v[60:63], v[76:79], v[108:111], v[60:63]
    v_and_b32_dpp v74, v68, v6 quad_perm:[1,1,1,1] row_mask:0xf bank_mask:0xf
    v_and_b32_dpp v75, v68, v7 quad_perm:[1,1,1,1] row_mask:0xf bank_mask:0xf
    v_and_b32_dpp v76, v69, v4 quad_perm:[1,1,1,1] row_mask:0xf bank_mask:0xf
    v_and_b32_dpp v77, v69, v5 quad_perm:[1,1,1,1] row_mask:0xf bank_mask:0xf
    v_mfma_f32_16x16x32_bf16 v[60:63], v[72:75], v[112:115], v[60:63]
    v_and_b32_dpp v78, v69, v6 quad_perm:[1,1,1,1] row_mask:0xf bank_mask:0xf
    v_and_b32_dpp v79, v69, v7 quad_perm:[1,1,1,1] row_mask:0xf bank_mask:0xf
    v_and_b32_dpp v72, v70, v4 quad_perm:[1,1,1,1] row_mask:0xf bank_mask:0xf
    v_and_b32_dpp v73, v70, v5 quad_perm:[1,1,1,1] row_mask:0xf bank_mask:0xf
    v_mfma_f32_16x16x32_bf16 v[60:63], v[76:79], v[116:119], v[60:63]
    v_and_b32_dpp v74, v70, v6 quad_perm:[1,1,1,1] row_mask:0xf bank_mask:0xf
    v_and_b32_dpp v75, v70, v7 quad_perm:[1,1,1,1] row_mask:0xf bank_mask:0xf
    v_and_b32_dpp v76, v71, v4 quad_perm:[1,1,1,1] row_mask:0xf bank_mask:0xf
    v_and_b32_dpp v77, v71, v5 quad_perm:[1,1,1,1] row_mask:0xf bank_mask:0xf
    v_mfma_f32_16x16x32_bf16 v[60:63], v[72:75], v[120:123], v[60:63]
    v_and_b32_dpp v78, v71, v6 quad_perm:[1,1,1,1] row_mask:0xf bank_mask:0xf
    v_and_b32_dpp v79, v71, v7 quad_perm:[1,1,1,1] row_mask:0xf bank_mask:0xf
    v_and_b32_dpp v72, v68, v4 quad_perm:[2,2,2,2] row_mask:0xf bank_mask:0xf
    v_and_b32_dpp v73, v68, v5 quad_perm:[2,2,2,2] row_mask:0xf bank_mask:0xf
    v_mfma_f32_16x16x32_bf16 v[60:63], v[76:79], v[124:127], v[60:63]
    v_and_b32_dpp v74, v68, v6 quad_perm:[2,2,2,2] row_mask:0xf bank_mask:0xf
    v_and_b32_dpp v75, v68, v7 quad_perm:[2,2,2,2] row_mask:0xf bank_mask:0xf
    v_and_b32_dpp v76, v69, v4 quad_perm:[2,2,2,2] row_mask:0xf bank_mask:0xf
    v_and_b32_dpp v77, v69, v5 quad_perm:[2,2,2,2] row_mask:0xf bank_mask:0xf
    v_mfma_f32_16x16x32_bf16 v[60:63], v[72:75], v[128:131], v[60:63]
    v_and_b32_dpp v78, v69, v6 quad_perm:[2,2,2,2] row_mask:0xf bank_mask:0xf
    v_and_b32_dpp v79, v69, v7 quad_perm:[2,2,2,2] row_mask:0xf bank_mask:0xf
    v_and_b32_dpp v72, v70, v4 quad_perm:[2,2,2,2] row_mask:0xf bank_mask:0xf
    v_and_b32_dpp v73, v70, v5 quad_perm:[2,2,2,2] row_mask:0xf bank_mask:0xf
    v_mfma_f32_16x16x32_bf16 v[60:63], v[76:79], v[132:135], v[60:63]
    v_and_b32_dpp v74, v70, v6 quad_perm:[2,2,2,2] row_mask:0xf bank_mask:0xf
    v_and_b32_dpp v75, v70, v7 quad_perm:[2,2,2,2] row_mask:0xf bank_mask:0xf
    v_and_b32_dpp v76, v71, v4 quad_perm:[2,2,2,2] row_mask:0xf bank_mask:0xf
    v_and_b32_dpp v77, v71, v5 quad_perm:[2,2,2,2] row_mask:0xf bank_mask:0xf
    v_mfma_f32_16x16x32_bf16 v[60:63], v[72:75], v[136:139], v[60:63]
    v_and_b32_dpp v78, v71, v6 quad_perm:[2,2,2,2] row_mask:0xf bank_mask:0xf
    v_and_b32_dpp v79, v71, v7 quad_perm:[2,2,2,2] row_mask:0xf bank_mask:0xf
    v_and_b32_dpp v72, v68, v4 quad_perm:[3,3,3,3] row_mask:0xf bank_mask:0xf
    v_and_b32_dpp v73, v68, v5 quad_perm:[3,3,3,3] row_mask:0xf bank_mask:0xf
    v_mfma_f32_16x16x32_bf16 v[60:63], v[76:79], v[140:143], v[60:63]
    v_and_b32_dpp v74, v68, v6 quad_perm:[3,3,3,3] row_mask:0xf bank_mask:0xf
    v_and_b32_dpp v75, v68, v7 quad_perm:[3,3,3,3] row_mask:0xf bank_mask:0xf
    v_and_b32_dpp v76, v69, v4 quad_perm:[3,3,3,3] row_mask:0xf bank_mask:0xf
    v_and_b32_dpp v77, v69, v5 quad_perm:[3,3,3,3] row_mask:0xf bank_mask:0xf
    v_mfma_f32_16x16x32_bf16 v[60:63], v[72:75], v[144:147], v[60:63]
    v_and_b32_dpp v78, v69, v6 quad_perm:[3,3,3,3] row_mask:0xf bank_mask:0xf
    v_and_b32_dpp v79, v69, v7 quad_perm:[3,3,3,3] row_mask:0xf bank_mask:0xf
    v_and_b32_dpp v72, v70, v4 quad_perm:[3,3,3,3] row_mask:0xf bank_mask:0xf
    v_and_b32_dpp v73, v70, v5 quad_perm:[3,3,3,3] row_mask:0xf bank_mask:0xf
    v_mfma_f32_16x16x32_bf16 v[60:63], v[76:79], v[148:151], v[60:63]
    v_and_b32_dpp v74, v70, v6 quad_perm:[3,3,3,3] row_mask:0xf bank_mask:0xf
    v_and_b32_dpp v75, v70, v7 quad_perm:[3,3,3,3] row_mask:0xf bank_mask:0xf
    v_and_b32_dpp v76, v71, v4 quad_perm:[3,3,3,3] row_mask:0xf bank_mask:0xf
    v_and_b32_dpp v77, v71, v5 quad_perm:[3,3,3,3] row_mask:0xf bank_mask:0xf
    v_mfma_f32_16x16x32_bf16 v[60:63], v[72:75], v[152:155], v[60:63]
    v_and_b32_dpp v78, v71, v6 quad_perm:[3,3,3,3] row_mask:0xf bank_mask:0xf
    v_and_b32_dpp v79, v71, v7 quad_perm:[3,3,3,3] row_mask:0xf bank_mask:0xf
    s_nop 1
    v_mfma_f32_16x16x32_bf16 v[60:63], v[76:79], v[156:159], v[60:63]
L_gred:
    s_nop 7
    ds_write_b128 v21, v[60:63] offset:11264
    s_mov_b64 exec, 1
    ds_add_rtn_u32 v26, v20, v27 offset:1792
    s_mov_b64 exec, -1
    ds_read_b128 v[28:31], v22 offset:11264
    ds_read_b128 v[32:35], v22 offset:12288
    ds_read_b128 v[36:39], v22 offset:13312
    s_waitcnt lgkmcnt(3)
    v_readfirstlane_b32 s10, v26
    s_cmp_lg_u32 s10, 2
    s_cbranch_scc1 L_fin
    s_waitcnt lgkmcnt(1)
    v_pk_add_f32 v[28:29], v[28:29], v[32:33]
    v_pk_add_f32 v[30:31], v[30:31], v[34:35]
    s_waitcnt lgkmcnt(0)
    v_pk_add_f32 v[28:29], v[28:29], v[36:37]
    v_pk_add_f32 v[30:31], v[30:31], v[38:39]
    v_and_or_b32 v28, v28, s14, v12
    buffer_store_dwordx4 v[28:31], v23, s[44:47], s60 offen sc1
    s_branch L_fin
L_ffn:
    s_add_u32 s10, s53, 32
    s_mul_i32 s10, s10, 5120
    s_add_u32 s60, s60, s10
    v_mul_u32_u24 v11, 61440, v8
    v_add_u32 v10, v10, v11
    s_mul_i32 s59, s53, 768
    s_lshl_b32 s10, s8, 8
    s_add_u32 s59, s59, s10
    s_add_u32 s59, s59, 28672
    s_add_u32 s56, s59, 30720
    v_and_b32 v11, 1, v1
    v_lshlrev_b32 v11, 4, v11
    v_bfe_u32 v16, s9, v11, 4
    v_add_u32 v17, 4, v11
    v_bfe_u32 v17, s9, v17, 4
    v_add_u32 v18, 8, v11
    v_bfe_u32 v18, s9, v18, 4
    v_add_u32 v19, 12, v11
    v_bfe_u32 v19, s9, v19, 4
    s_mov_b32 s11, 65536
L_fpoll:
    buffer_load_dwordx4 v[28:31], v10, s[44:47], s59 offen sc1
    buffer_load_dwordx4 v[32:35], v10, s[44:47], s56 offen sc1
    s_waitcnt vmcnt(0)
    v_xor_b32 v28, v28, v16
    v_xor_b32 v29, v29, v17
    v_xor_b32 v30, v30, v18
    v_xor_b32 v31, v31, v19
    v_xor_b32 v32, v32, v16
    v_xor_b32 v33, v33, v17
    v_xor_b32 v34, v34, v18
    v_xor_b32 v35, v35, v19
    v_or3_b32 v26, v28, v29, v30
    v_or3_b32 v26, v26, v31, v32
    v_or3_b32 v26, v26, v33, v34
    v_or_b32 v26, v26, v35
    v_and_b32 v26, 15, v26
    v_cmp_ne_u32 vcc, 0, v26
    s_cbranch_vccz L_fok
    s_sub_u32 s11, s11, 1
    s_cmp_lg_u32 s11, 0
    s_cbranch_scc1 L_fpoll
L_fok:
    v_add_f32_dpp v28, v28, v28 row_ror:4 row_mask:0xf bank_mask:0xf
    v_add_f32_dpp v29, v29, v29 row_ror:4 row_mask:0xf bank_mask:0xf
    v_add_f32_dpp v30, v30, v30 row_ror:4 row_mask:0xf bank_mask:0xf
    v_add_f32_dpp v31, v31, v31 row_ror:4 row_mask:0xf bank_mask:0xf
    v_add_f32_dpp v32, v32, v32 row_ror:4 row_mask:0xf bank_mask:0xf
    v_add_f32_dpp v33, v33, v33 row_ror:4 row_mask:0xf bank_mask:0xf
    v_add_f32_dpp v34, v34, v34 row_ror:4 row_mask:0xf bank_mask:0xf
    v_add_f32_dpp v35, v35, v35 row_ror:4 row_mask:0xf bank_mask:0xf
    v_add_f32_dpp v68, v28, v28 row_ror:8 row_mask:0xf bank_mask:0xf
    v_add_f32_dpp v69, v29, v29 row_ror:8 row_mask:0xf bank_mask:0xf
    v_add_f32_dpp v70, v30, v30 row_ror:8 row_mask:0xf bank_mask:0xf
    v_add_f32_dpp v71, v31, v31 row_ror:8 row_mask:0xf bank_mask:0xf
    v_add_f32_dpp v68, v32, v32 row_ror:8 row_mask:0xf bank_mask:0xc
    v_add_f32_dpp v69, v33, v33 row_ror:8 row_mask:0xf bank_mask:0xc
    v_add_f32_dpp v70, v34, v34 row_ror:8 row_mask:0xf bank_mask:0xc
    v_add_f32_dpp v71, v35, v35 row_ror:8 row_mask:0xf bank_mask:0xc
    v_max_f32 v68, 0, v68
    v_max_f32 v69, 0, v69
    v_max_f32 v70, 0, v70
    v_max_f32 v71, 0, v71
    s_branch L_late
L_bump:
    v_lshlrev_b32 v10, 8, v1
    s_mov_b32 s63, 4194304
    v_mov_b32 v2, 8
L_lw7:
    ds_read_b32 v26, v2 offset:1792
    s_waitcnt lgkmcnt(0)
    v_readfirstlane_b32 s10, v26
    s_cmp_ge_u32 s10, 4
    s_cbranch_scc1 L_lw7_d
    s_sub_u32 s63, s63, 1
    s_cmp_lg_u32 s63, 0
    s_cbranch_scc1 L_lw7
L_lw7_d:
    s_mov_b32 s11, 65536
    s_mov_b32 s58, 491520
L_bpoll:
    buffer_load_dword v16, v10, s[44:47], s58 offen offset:8 sc1
    buffer_load_dword v17, v10, s[44:47], s58 offen offset:72 sc1
    buffer_load_dword v18, v10, s[44:47], s58 offen offset:136 sc1
    buffer_load_dword v19, v10, s[44:47], s58 offen offset:200 sc1
    s_waitcnt vmcnt(0)
    v_xor_b32 v16, s9, v16
    v_xor_b32 v17, s9, v17
    v_xor_b32 v18, s9, v18
    v_xor_b32 v19, s9, v19
    v_or3_b32 v16, v16, v17, v18
    v_or_b32 v16, v16, v19
    v_cmp_ne_u32 vcc, 0, v16
    s_cbranch_vccz L_bok
    s_sub_u32 s11, s11, 1
    s_cmp_lg_u32 s11, 0
    s_cbranch_scc1 L_bpoll
L_bok:
    v_mov_b32 v16, s9
    v_mov_b32 v17, 0
    s_mov_b64 exec, 1
    buffer_store_dword v16, v17, s[44:47], 0 offen sc1
    s_branch L_fin
L_merger:
    s_mul_i32 s95, s4, 5
    s_add_u32 s95, s95, s7
    s_sub_u32 s95, s95, 10
    v_lshrrev_b32 v100, 2, v1
    v_mul_u32_u24 v100, 5120, v100
    v_lshl_add_u32 v100, v9, 4, v100
    v_cmp_gt_u32 vcc, 32, v1
    v_mov_b32 v101, 0x40000000
    s_nop 0
    v_cndmask_b32 v101, v101, v100, vcc
    v_cndmask_b32 v102, 0, v12, vcc
    s_lshl_b32 s96, s95, 6
    s_add_u32 s96, s96, 262144
    s_add_u32 s97, s96, 81920
    s_add_u32 s98, s96, 163840
    v_lshrrev_b32 v8, 5, v1
    v_bfe_u32 v14, v1, 4, 1
    v_lshl_add_u32 v8, v14, 1, v8
    v_lshl_add_u32 v8, v9, 2, v8
    v_lshlrev_b32 v103, 1, v8
    s_lshl_b32 s95, s95, 5
    s_and_b32 s95, s95, 0xfff
    buffer_load_ushort v104, v103, s[48:51], s95 offen
    s_mov_b32 s36, s32
    s_mov_b32 s37, s33
    s_mov_b32 s38, 2560
    s_mov_b32 s39, 0x20000
    v_bfe_u32 v8, v1, 2, 2
    v_lshlrev_b32 v10, 5, v8
    v_lshl_add_u32 v10, v9, 2, v10
    v_lshlrev_b32 v11, 4, v8
    s_lshl_b32 s58, s4, 4
    s_add_u32 s58, s58, s7
    s_lshl_b32 s55, s58, 6
    s_add_u32 s55, s55, 491520
    s_mul_i32 s58, s58, 768
    s_add_u32 s58, s58, 524288
    v_lshlrev_b32 v23, 4, v1
    v_mov_b32 v22, v23
    s_getreg_b32 s59, hwreg(HW_REG_XCC_ID)
    s_mov_b32 s63, 4194304
    v_mov_b32 v2, 0
L_lw8:
    ds_read_b32 v26, v2 offset:1792
    s_waitcnt lgkmcnt(0)
    v_readfirstlane_b32 s10, v26
    s_cmp_ge_u32 s10, 4
    s_cbranch_scc1 L_lw8_d
    s_sub_u32 s63, s63, 1
    s_cmp_lg_u32 s63, 0
    s_cbranch_scc1 L_lw8
L_lw8_d:
    ds_read_b32 v14, v10 offset:1536
    ds_read_b32 v15, v10 offset:1552
    s_waitcnt vmcnt(0) lgkmcnt(0)
    v_lshlrev_b32 v104, 16, v104
    v_max_f32_dpp v16, v14, v14 quad_perm:[1,0,3,2] row_mask:0xf bank_mask:0xf
    s_nop 1
    v_max_f32_dpp v16, v16, v16 quad_perm:[2,3,0,1] row_mask:0xf bank_mask:0xf
    v_sub_f32 v14, v14, v16
    v_mul_f32 v14, s15, v14
    v_exp_f32 v14, v14
    s_nop 0
    v_mul_f32 v17, v14, v15
    s_nop 1
    v_add_f32_dpp v17, v17, v17 quad_perm:[1,0,3,2] row_mask:0xf bank_mask:0xf
    s_nop 1
    v_add_f32_dpp v17, v17, v17 quad_perm:[2,3,0,1] row_mask:0xf bank_mask:0xf
    v_mov_b32 v18, s9
    v_mov_b32 v19, s59
    s_mov_b64 exec, 0x1111
    buffer_store_dwordx4 v[16:19], v11, s[44:47], s55 offen sc1
    s_mov_b64 exec, 0xffff
    s_mov_b32 s63, 4194304
    v_mov_b32 v2, 4
L_lw9:
    ds_read_b32 v26, v2 offset:1792
    s_waitcnt lgkmcnt(0)
    v_readfirstlane_b32 s10, v26
    s_cmp_ge_u32 s10, 4
    s_cbranch_scc1 L_lw9_d
    s_sub_u32 s63, s63, 1
    s_cmp_lg_u32 s63, 0
    s_cbranch_scc1 L_lw9
L_lw9_d:
    s_and_b32 s55, s55, 0xfffffc00
    s_mov_b32 s11, 65536
    v_lshlrev_b32 v13, 6, v1
L_xpoll:
    buffer_load_dwordx2 v[16:17], v13, s[44:47], s55 offen offset:8 sc1
    s_waitcnt vmcnt(0)
    v_cmp_ne_u32 vcc, s9, v16
    s_cbranch_vccz L_xok
    s_sub_u32 s11, s11, 1
    s_cmp_lg_u32 s11, 0
    s_cbranch_scc1 L_xpoll
L_xok:
    v_cmp_ne_u32 s[60:61], s59, v17
    s_or_b64 s[60:61], s[60:61], vcc
    s_mov_b32 exec_lo, -1
    s_mov_b32 exec_hi, 0xffff
    s_mov_b32 s56, 0
L_mloop:
    v_readlane_b32 s10, v14, s56
    s_add_u32 s56, s56, 1
    s_nop 0
    v_mov_b32 v64, s10
    v_readlane_b32 s10, v14, s56
    s_add_u32 s56, s56, 1
    s_nop 0
    v_mov_b32 v66, s10
    v_readlane_b32 s10, v14, s56
    s_add_u32 s56, s56, 1
    s_nop 0
    v_mov_b32 v68, s10
    v_readlane_b32 s10, v14, s56
    s_add_u32 s56, s56, 1
    s_nop 0
    v_mov_b32 v70, s10
    s_cmp_eq_u32 s56, 16
    s_cbranch_scc1 L_mlast
    s_cmp_eq_u32 s56, 4
    s_cbranch_scc1 L_mgo
    s_mov_b32 s63, 4194304
    v_mov_b32 v2, s56
L_lw10:
    ds_read_b32 v26, v2 offset:1792
    s_waitcnt lgkmcnt(0)
    v_readfirstlane_b32 s10, v26
    s_cmp_ge_u32 s10, 4
    s_cbranch_scc1 L_lw10_d
    s_sub_u32 s63, s63, 1
    s_cmp_lg_u32 s63, 0
    s_cbranch_scc1 L_lw10
L_lw10_d:
    s_branch L_mgo
L_mlast:
    s_mov_b32 s63, 4194304
    v_mov_b32 v2, s56
L_lw11:
    ds_read_b32 v26, v2 offset:1792
    s_waitcnt lgkmcnt(0)
    v_readfirstlane_b32 s10, v26
    s_cmp_ge_u32 s10, 1
    s_cbranch_scc1 L_lw11_d
    s_sub_u32 s63, s63, 1
    s_cmp_lg_u32 s63, 0
    s_cbranch_scc1 L_lw11
L_lw11_d:
L_mgo:
    s_mov_b32 s63, 4194304
    v_mov_b32 v2, s56
L_mrd:
    ds_read_b32 v26, v2 offset:1792
    ds_read_b128 v[28:31], v22 offset:17408
    ds_read_b128 v[32:35], v22 offset:18176
    ds_read_b128 v[36:39], v22 offset:18944
    ds_read_b128 v[40:43], v22 offset:19712
    ds_read_b128 v[44:47], v22 offset:20480
    ds_read_b128 v[48:51], v22 offset:21248
    ds_read_b128 v[52:55], v22 offset:22016
    ds_read_b128 v[56:59], v22 offset:22784
    s_waitcnt lgkmcnt(8)
    v_readfirstlane_b32 s10, v26
    s_cmp_ge_u32 s10, 4
    s_cbranch_scc1 L_mok
    s_sub_u32 s63, s63, 1
    s_cmp_lg_u32 s63, 0
    s_waitcnt lgkmcnt(4)
    s_cbranch_scc1 L_mrd
L_mok:
    s_cmp_lg_u64 s[60:61], 0
    s_waitcnt lgkmcnt(6)
    v_pk_add_f32 v[28:29], v[28:29], v[32:33]
    v_pk_add_f32 v[30:31], v[30:31], v[34:35]
    v_pk_mul_f32 v[60:61], v[28:29], v[64:65] op_sel_hi:[1,0]
    v_pk_mul_f32 v[62:63], v[30:31], v[64:65] op_sel_hi:[1,0]
    s_waitcnt lgkmcnt(4)
    v_pk_add_f32 v[36:37], v[36:37], v[40:41]
    v_pk_add_f32 v[38:39], v[38:39], v[42:43]
    v_pk_fma_f32 v[60:61], v[36:37], v[66:67], v[60:61] op_sel_hi:[1,0,1]
    v_pk_fma_f32 v[62:63], v[38:39], v[66:67], v[62:63] op_sel_hi:[1,0,1]
    s_waitcnt lgkmcnt(2)
    v_pk_add_f32 v[44:45], v[44:45], v[48:49]
    v_pk_add_f32 v[46:47], v[46:47], v[50:51]
    v_pk_fma_f32 v[60:61], v[44:45], v[68:69], v[60:61] op_sel_hi:[1,0,1]
    v_pk_fma_f32 v[62:63], v[46:47], v[68:69], v[62:63] op_sel_hi:[1,0,1]
    s_waitcnt lgkmcnt(0)
    v_pk_add_f32 v[52:53], v[52:53], v[56:57]
    v_pk_add_f32 v[54:55], v[54:55], v[58:59]
    v_pk_fma_f32 v[60:61], v[52:53], v[70:71], v[60:61] op_sel_hi:[1,0,1]
    v_pk_fma_f32 v[62:63], v[54:55], v[70:71], v[62:63] op_sel_hi:[1,0,1]
    v_and_or_b32 v60, v60, s14, v12
    s_cbranch_scc1 L_mfar
    buffer_store_dwordx4 v[60:63], v23, s[44:47], s58 offen
L_mst:
    v_add_u32 v22, 6144, v22
    s_add_u32 s58, s58, 196608
    s_cmp_lt_u32 s56, 16
    s_cbranch_scc1 L_mloop
    s_mov_b64 exec, 1
    v_mov_b32 v26, 1
    ds_add_u32 v2, v26 offset:1792
    s_mov_b64 exec, -1
    s_sub_u32 s10, s7, 10
    s_cmp_ge_u32 s10, 5
    s_cbranch_scc1 L_fin
    s_mov_b32 s11, 65536
L_ypoll:
    buffer_load_dwordx4 v[24:27], v101, s[44:47], s98 offen sc1
    buffer_load_dwordx4 v[16:19], v100, s[44:47], s96 offen sc1
    buffer_load_dwordx4 v[20:23], v100, s[44:47], s97 offen sc1
    s_waitcnt vmcnt(0)
    v_xor_b32 v24, v24, v102
    v_xor_b32 v16, v16, v12
    v_xor_b32 v20, v20, v12
    v_or3_b32 v28, v16, v20, v24
    v_and_b32 v28, 0xff, v28
    v_cmp_ne_u32 vcc, 0, v28
    s_cbranch_vccz L_yok
    s_sub_u32 s11, s11, 1
    s_cmp_lg_u32 s11, 0
    s_cbranch_scc1 L_ypoll
L_yok:
    v_pk_add_f32 v[16:17], v[16:17], v[20:21]
    v_pk_add_f32 v[18:19], v[18:19], v[22:23]
    v_permlane32_swap_b32 v24, v25
    v_permlane32_swap_b32 v26, v27
    v_permlane32_swap_b32 v16, v17
    v_permlane32_swap_b32 v18, v19
    v_add_f32 v24, v24, v25
    v_add_f32 v26, v26, v27
    v_add_f32 v16, v16, v17
    v_add_f32 v18, v18, v19
    v_permlane16_swap_b32 v24, v26
    s_nop 0
    v_permlane16_swap_b32 v16, v18
    v_add_f32 v24, v24, v26
    v_add_f32 v16, v16, v18
    s_nop 0
    v_add_f32_dpp v24, v24, v24 row_ror:8 row_mask:0xf bank_mask:0xf
    v_add_f32_dpp v16, v16, v16 row_ror:8 row_mask:0xf bank_mask:0xf
    s_nop 0
    v_add_f32_dpp v24, v24, v24 row_ror:4 row_mask:0xf bank_mask:0xf
    v_add_f32_dpp v16, v16, v16 row_ror:4 row_mask:0xf bank_mask:0xf
    v_cvt_pk_bf16_f32 v16, v24, v16
    v_and_b32 v17, s13, v16
    v_lshlrev_b32 v16, 16, v16
    v_add_f32 v17, v104, v17
    v_cvt_pk_bf16_f32 v17, v17, v17
    v_and_b32 v17, s13, v17
    v_add_f32 v17, v17, v16
    v_cvt_pk_bf16_f32 v17, v17, v17
    s_mov_b32 exec_lo, 0x000f000f
    s_mov_b32 exec_hi, 0x000f000f
    buffer_store_short v17, v103, s[36:39], s95 offen
    s_endpgm
L_mfar:
    buffer_store_dwordx4 v[60:63], v23, s[44:47], s58 offen sc1
    s_branch L_mst
L_stream:
    s_waitcnt vmcnt(6)
    buffer_load_dwordx4 v[72:75], v2, s[36:39], s12 offen offset:128 nt
    s_waitcnt vmcnt(6)
    buffer_load_dwordx4 v[76:79], v2, s[36:39], s12 offen offset:256 nt
    s_add_u32 s40, s40, 1
    s_and_b32 s40, s40, 15
    s_cselect_b32 s41, s42, 12288
    s_add_u32 s12, s12, s41
    s_add_u32 s54, s54, 1
    s_and_b32 s54, s54, 15
    s_cselect_b32 s41, 0, 3145728
    s_sub_u32 s12, s12, s41
    s_waitcnt vmcnt(6)
    buffer_load_dwordx4 v[80:83], v2, s[36:39], s12 offen offset:0 nt
    s_setprio 1
    v_and_b32 v12, 1, v1
    v_lshlrev_b32 v12, 4, v12
    v_mov_b32 v13, 0xffff
    v_lshlrev_b32 v13, v12, v13
    v_bfe_u32 v12, v1, 1, 2
    v_cmp_eq_u32 vcc, 0, v12
    s_nop 1
    v_cndmask_b32 v4, 0, v13, vcc
    v_cmp_eq_u32 vcc, 1, v12
    s_nop 1
    v_cndmask_b32 v5, 0, v13, vcc
    v_cmp_eq_u32 vcc, 2, v12
    s_nop 1
    v_cndmask_b32 v6, 0, v13, vcc
    v_cmp_eq_u32 vcc, 3, v12
    s_nop 1
    v_cndmask_b32 v7, 0, v13, vcc
    s_mov_b32 s13, 0xffff0000
    s_mov_b32 s14, 0x3d93cd3a
    s_mov_b32 s15, 0x3fb8aa3b
    v_mov_b32 v20, 0
    v_mov_b32 v21, 0
    v_mov_b32 v22, 0
    v_mov_b32 v23, 0
    v_mov_b32 v24, 0
    v_mov_b32 v25, 0
    v_mov_b32 v26, 0
    v_mov_b32 v27, 0
    v_mov_b32 v28, 0
    v_mov_b32 v29, 0
    v_mov_b32 v30, 0
    v_mov_b32 v31, 0
    v_lshlrev_b32 v14, 4, v10
    s_lshl_b32 s6, s8, 11
    s_add_u32 s6, s6, 3072
    v_lshrrev_b32 v3, 3, v1
    v_lshl_add_u32 v3, v3, 6, s6
    s_mov_b32 s5, 4
    v_mov_b32 v15, 0
    s_mov_b32 s56, 0xbe30b19f
    s_mov_b32 s57, 0x43a3c39f
    s_lshr_b64 s[56:57], s[56:57], s58
    s_and_b32 s59, s56, 15
    s_lshl_b32 s59, s59, 4
    s_or_b32 s55, s55, s59
    s_mov_b32 s56, 0xb190b19f
    s_mov_b32 s57, 0xc1a0c39f
    s_lshr_b64 s[56:57], s[56:57], s58
    s_and_b32 s59, s56, 15
    s_lshl_b32 s59, s59, 8
    s_or_b32 s55, s55, s59
    s_mov_b32 s56, 0xb190b19f
    s_mov_b32 s57, 0xc3a0c39f
    s_lshr_b64 s[56:57], s[56:57], s58
    s_and_b32 s59, s56, 15
    s_lshl_b32 s59, s59, 12
    s_or_b32 s55, s55, s59
    s_mul_i32 s55, s55, 0x10001
    s_waitcnt vmcnt(6)
    buffer_load_dwordx4 v[84:87], v2, s[36:39], s12 offen offset:128 nt
    s_waitcnt vmcnt(6)
    buffer_load_dwordx4 v[88:91], v2, s[36:39], s12 offen offset:256 nt
    s_add_u32 s40, s40, 1
    s_and_b32 s40, s40, 15
    s_cselect_b32 s41, s42, 12288
    s_add_u32 s12, s12, s41
    s_add_u32 s54, s54, 1
    s_and_b32 s54, s54, 15
    s_cselect_b32 s41, 0, 3145728
    s_sub_u32 s12, s12, s41
    s_waitcnt vmcnt(6)
    buffer_load_dwordx4 v[92:95], v2, s[36:39], s12 offen offset:0 nt
    s_waitcnt vmcnt(6)
    buffer_load_dwordx4 v[96:99], v2, s[36:39], s12 offen offset:128 nt
    s_waitcnt vmcnt(6)
    buffer_load_dwordx4 v[100:103], v2, s[36:39], s12 offen offset:256 nt
    s_add_u32 s40, s40, 1
    s_and_b32 s40, s40, 15
    s_cselect_b32 s41, s42, 12288
    s_add_u32 s12, s12, s41
    s_add_u32 s54, s54, 1
    s_and_b32 s54, s54, 15
    s_cselect_b32 s41, 0, 3145728
    s_sub_u32 s12, s12, s41
    s_waitcnt vmcnt(6)
    buffer_load_dwordx4 v[104:107], v2, s[36:39], s12 offen offset:0 nt
    s_waitcnt vmcnt(6)
    buffer_load_dwordx4 v[108:111], v2, s[36:39], s12 offen offset:128 nt
    s_waitcnt vmcnt(6)
    buffer_load_dwordx4 v[112:115], v2, s[36:39], s12 offen offset:256 nt
    s_add_u32 s40, s40, 1
    s_and_b32 s40, s40, 15
    s_cselect_b32 s41, s42, 12288
    s_add_u32 s12, s12, s41
    s_add_u32 s54, s54, 1
    s_and_b32 s54, s54, 15
    s_cselect_b32 s41, 0, 3145728
    s_sub_u32 s12, s12, s41
    s_waitcnt vmcnt(6)
    buffer_load_dwordx4 v[116:119], v2, s[36:39], s12 offen offset:0 nt
    s_waitcnt vmcnt(6)
    buffer_load_dwordx4 v[120:123], v2, s[36:39], s12 offen offset:128 nt
    s_waitcnt vmcnt(6)
    buffer_load_dwordx4 v[124:127], v2, s[36:39], s12 offen offset:256 nt
    s_add_u32 s40, s40, 1
    s_and_b32 s40, s40, 15
    s_cselect_b32 s41, s42, 12288
    s_add_u32 s12, s12, s41
    s_add_u32 s54, s54, 1
    s_and_b32 s54, s54, 15
    s_cselect_b32 s41, 0, 3145728
    s_sub_u32 s12, s12, s41
    s_waitcnt vmcnt(6)
    buffer_load_dwordx4 v[128:131], v2, s[36:39], s12 offen offset:0 nt
    s_waitcnt vmcnt(6)
    buffer_load_dwordx4 v[132:135], v2, s[36:39], s12 offen offset:128 nt
    s_waitcnt vmcnt(6)
    buffer_load_dwordx4 v[136:139], v2, s[36:39], s12 offen offset:256 nt
    s_add_u32 s40, s40, 1
    s_and_b32 s40, s40, 15
    s_cselect_b32 s41, s42, 12288
    s_add_u32 s12, s12, s41
    s_add_u32 s54, s54, 1
    s_and_b32 s54, s54, 15
    s_cselect_b32 s41, 0, 3145728
    s_sub_u32 s12, s12, s41
    s_waitcnt vmcnt(6)
    buffer_load_dwordx4 v[140:143], v2, s[36:39], s12 offen offset:0 nt
    s_waitcnt vmcnt(6)
    buffer_load_dwordx4 v[144:147], v2, s[36:39], s12 offen offset:128 nt
    s_waitcnt vmcnt(6)
    buffer_load_dwordx4 v[148:151], v2, s[36:39], s12 offen offset:256 nt
    s_add_u32 s40, s40, 1
    s_and_b32 s40, s40, 15
    s_cselect_b32 s41, s42, 12288
    s_add_u32 s12, s12, s41
    s_add_u32 s54, s54, 1
    s_and_b32 s54, s54, 15
    s_cselect_b32 s41, 0, 3145728
    s_sub_u32 s12, s12, s41
    s_waitcnt vmcnt(6)
    buffer_load_dwordx4 v[152:155], v2, s[36:39], s12 offen offset:0 nt
    s_waitcnt vmcnt(6)
    buffer_load_dwordx4 v[156:159], v2, s[36:39], s12 offen offset:128 nt
    s_waitcnt vmcnt(6)
    buffer_load_dwordx4 v[160:163], v2, s[36:39], s12 offen offset:256 nt
    s_add_u32 s40, s40, 1
    s_and_b32 s40, s40, 15
    s_cselect_b32 s41, s42, 12288
    s_add_u32 s12, s12, s41
    s_add_u32 s54, s54, 1
    s_and_b32 s54, s54, 15
    s_cselect_b32 s41, 0, 3145728
    s_sub_u32 s12, s12, s41
    s_waitcnt vmcnt(6)
    buffer_load_dwordx4 v[164:167], v2, s[36:39], s12 offen offset:0 nt
    s_waitcnt vmcnt(6)
    buffer_load_dwordx4 v[168:171], v2, s[36:39], s12 offen offset:128 nt
    s_waitcnt vmcnt(6)
    buffer_load_dwordx4 v[172:175], v2, s[36:39], s12 offen offset:256 nt
    s_add_u32 s40, s40, 1
    s_and_b32 s40, s40, 15
    s_cselect_b32 s41, s42, 12288
    s_add_u32 s12, s12, s41
    s_add_u32 s54, s54, 1
    s_and_b32 s54, s54, 15
    s_cselect_b32 s41, 0, 3145728
    s_sub_u32 s12, s12, s41
    s_waitcnt vmcnt(6)
    buffer_load_dwordx4 v[176:179], v2, s[36:39], s12 offen offset:0 nt
    s_waitcnt vmcnt(6)
    buffer_load_dwordx4 v[180:183], v2, s[36:39], s12 offen offset:128 nt
    s_waitcnt vmcnt(6)
    buffer_load_dwordx4 v[184:187], v2, s[36:39], s12 offen offset:256 nt
    s_add_u32 s40, s40, 1
    s_and_b32 s40, s40, 15
    s_cselect_b32 s41, s42, 12288
    s_add_u32 s12, s12, s41
    s_add_u32 s54, s54, 1
    s_and_b32 s54, s54, 15
    s_cselect_b32 s41, 0, 3145728
    s_sub_u32 s12, s12, s41
    s_waitcnt vmcnt(6)
    buffer_load_dwordx4 v[188:191], v2, s[36:39], s12 offen offset:0 nt
    s_waitcnt vmcnt(6)
    buffer_load_dwordx4 v[192:195], v2, s[36:39], s12 offen offset:128 nt
    s_waitcnt vmcnt(6)
    buffer_load_dwordx4 v[196:199], v2, s[36:39], s12 offen offset:256 nt
    s_add_u32 s40, s40, 1
    s_and_b32 s40, s40, 15
    s_cselect_b32 s41, s42, 12288
    s_add_u32 s12, s12, s41
    s_add_u32 s54, s54, 1
    s_and_b32 s54, s54, 15
    s_cselect_b32 s41, 0, 3145728
    s_sub_u32 s12, s12, s41
    s_waitcnt vmcnt(6)
    buffer_load_dwordx4 v[200:203], v2, s[36:39], s12 offen offset:0 nt
    s_waitcnt vmcnt(6)
    buffer_load_dwordx4 v[204:207], v2, s[36:39], s12 offen offset:128 nt
    s_waitcnt vmcnt(6)
    buffer_load_dwordx4 v[208:211], v2, s[36:39], s12 offen offset:256 nt
    s_add_u32 s40, s40, 1
    s_and_b32 s40, s40, 15
    s_cselect_b32 s41, s42, 12288
    s_add_u32 s12, s12, s41
    s_add_u32 s54, s54, 1
    s_and_b32 s54, s54, 15
    s_cselect_b32 s41, 0, 3145728
    s_sub_u32 s12, s12, s41
    s_waitcnt vmcnt(6)
    buffer_load_dwordx4 v[212:215], v2, s[36:39], s12 offen offset:0 nt
    s_waitcnt vmcnt(6)
    buffer_load_dwordx4 v[216:219], v2, s[36:39], s12 offen offset:128 nt
    s_waitcnt vmcnt(6)
    buffer_load_dwordx4 v[220:223], v2, s[36:39], s12 offen offset:256 nt
    s_add_u32 s40, s40, 1
    s_and_b32 s40, s40, 15
    s_cselect_b32 s41, s42, 12288
    s_add_u32 s12, s12, s41
    s_add_u32 s54, s54, 1
    s_and_b32 s54, s54, 15
    s_cselect_b32 s41, 0, 3145728
    s_sub_u32 s12, s12, s41
    s_waitcnt vmcnt(6)
    buffer_load_dwordx4 v[224:227], v2, s[36:39], s12 offen offset:0 nt
    s_waitcnt vmcnt(6)
    buffer_load_dwordx4 v[228:231], v2, s[36:39], s12 offen offset:128 nt
    s_waitcnt vmcnt(6)
    buffer_load_dwordx4 v[232:235], v2, s[36:39], s12 offen offset:256 nt
    s_add_u32 s40, s40, 1
    s_and_b32 s40, s40, 15
    s_cselect_b32 s41, s42, 12288
    s_add_u32 s12, s12, s41
    s_add_u32 s54, s54, 1
    s_and_b32 s54, s54, 15
    s_cselect_b32 s41, 0, 3145728
    s_sub_u32 s12, s12, s41
    s_lshr_b32 s55, s55, 4
    s_and_b32 s41, s55, 15
    s_sub_u32 s54, s41, s54
    s_mul_i32 s54, s54, 196608
    s_add_u32 s12, s12, s54
    s_mov_b32 s54, s41
    s_add_u32 s12, s12, 50331648
    s_mov_b32 s11, 4194304
L_qwait:
    ds_read_b32 v12, v15 offset:1824
    ds_read_b128 v[32:35], v14 offset:0
    ds_read_b128 v[36:39], v14 offset:128
    ds_read_b128 v[40:43], v14 offset:256
    s_waitcnt lgkmcnt(0)
    v_readfirstlane_b32 s10, v12
    s_cmp_lg_u32 s10, 0
    s_cbranch_scc1 L_qhave
    s_sub_u32 s11, s11, 1
    s_cmp_lg_u32 s11, 0
    s_cbranch_scc1 L_qwait
L_qhave:
    v_dot2_f32_bf16 v8, v44, v32, 0
    v_dot2_f32_bf16 v9, v56, v32, 0
    v_dot2_f32_bf16 v10, v68, v32, 0
    v_dot2_f32_bf16 v11, v80, v32, 0
    v_dot2c_f32_bf16 v8, v45, v33
    v_dot2c_f32_bf16 v9, v57, v33
    v_dot2c_f32_bf16 v10, v69, v33
    v_dot2c_f32_bf16 v11, v81, v33
    v_dot2c_f32_bf16 v8, v46, v34
    v_dot2c_f32_bf16 v9, v58, v34
    v_dot2c_f32_bf16 v10, v70, v34
    v_dot2c_f32_bf16 v11, v82, v34
    v_dot2c_f32_bf16 v8, v47, v35
    v_dot2c_f32_bf16 v9, v59, v35
    v_dot2c_f32_bf16 v10, v71, v35
    v_dot2c_f32_bf16 v11, v83, v35
    v_dot2c_f32_bf16 v8, v48, v36
    v_dot2c_f32_bf16 v9, v60, v36
    v_dot2c_f32_bf16 v10, v72, v36
    v_dot2c_f32_bf16 v11, v84, v36
    v_dot2c_f32_bf16 v8, v49, v37
    v_dot2c_f32_bf16 v9, v61, v37
    v_dot2c_f32_bf16 v10, v73, v37
    v_dot2c_f32_bf16 v11, v85, v37
    v_dot2c_f32_bf16 v8, v50, v38
    v_dot2c_f32_bf16 v9, v62, v38
    v_dot2c_f32_bf16 v10, v74, v38
    v_dot2c_f32_bf16 v11, v86, v38
    v_dot2c_f32_bf16 v8, v51, v39
    v_dot2c_f32_bf16 v9, v63, v39
    v_dot2c_f32_bf16 v10, v75, v39
    v_dot2c_f32_bf16 v11, v87, v39
    v_dot2c_f32_bf16 v8, v52, v40
    v_dot2c_f32_bf16 v9, v64, v40
    v_dot2c_f32_bf16 v10, v76, v40
    v_dot2c_f32_bf16 v11, v88, v40
    v_dot2c_f32_bf16 v8, v53, v41
    v_dot2c_f32_bf16 v9, v65, v41
    v_dot2c_f32_bf16 v10, v77, v41
    v_dot2c_f32_bf16 v11, v89, v41
    v_dot2c_f32_bf16 v8, v54, v42
    v_dot2c_f32_bf16 v9, v66, v42
    v_dot2c_f32_bf16 v10, v78, v42
    v_dot2c_f32_bf16 v11, v90, v42
    v_dot2c_f32_bf16 v8, v55, v43
    v_dot2c_f32_bf16 v9, v67, v43
    v_dot2c_f32_bf16 v10, v79, v43
    v_dot2c_f32_bf16 v11, v91, v43
    v_add_f32_dpp v8, v8, v8 quad_perm:[1,0,3,2] row_mask:0xf bank_mask:0xf
    v_add_f32_dpp v9, v9, v9 quad_perm:[1,0,3,2] row_mask:0xf bank_mask:0xf
    v_add_f32_dpp v10, v10, v10 quad_perm:[1,0,3,2] row_mask:0xf bank_mask:0xf
    v_add_f32_dpp v11, v11, v11 quad_perm:[1,0,3,2] row_mask:0xf bank_mask:0xf
    v_add_f32_dpp v8, v8, v8 quad_perm:[2,3,0,1] row_mask:0xf bank_mask:0xf
    v_add_f32_dpp v9, v9, v9 quad_perm:[2,3,0,1] row_mask:0xf bank_mask:0xf
    v_add_f32_dpp v10, v10, v10 quad_perm:[2,3,0,1] row_mask:0xf bank_mask:0xf
    v_add_f32_dpp v11, v11, v11 quad_perm:[2,3,0,1] row_mask:0xf bank_mask:0xf
    v_add_f32_dpp v8, v8, v8 row_half_mirror row_mask:0xf bank_mask:0xf
    v_add_f32_dpp v9, v9, v9 row_half_mirror row_mask:0xf bank_mask:0xf
    v_add_f32_dpp v10, v10, v10 row_half_mirror row_mask:0xf bank_mask:0xf
    v_add_f32_dpp v11, v11, v11 row_half_mirror row_mask:0xf bank_mask:0xf
    ds_write_b128 v3, v[8:11]
    v_add_u32 v3, 16, v3
    buffer_load_dwordx4 v[44:47], v2, s[36:39], s12 offen offset:0 nt
    buffer_load_dwordx4 v[48:51], v2, s[36:39], s12 offen offset:128 nt
    v_dot2_f32_bf16 v8, v92, v32, 0
    v_dot2_f32_bf16 v9, v104, v32, 0
    v_dot2_f32_bf16 v10, v116, v32, 0
    v_dot2_f32_bf16 v11, v128, v32, 0
    v_dot2c_f32_bf16 v8, v93, v33
    v_dot2c_f32_bf16 v9, v105, v33
    v_dot2c_f32_bf16 v10, v117, v33
    v_dot2c_f32_bf16 v11, v129, v33
    v_dot2c_f32_bf16 v8, v94, v34
    v_dot2c_f32_bf16 v9, v106, v34
    v_dot2c_f32_bf16 v10, v118, v34
    v_dot2c_f32_bf16 v11, v130, v34
    v_dot2c_f32_bf16 v8, v95, v35
    v_dot2c_f32_bf16 v9, v107, v35
    v_dot2c_f32_bf16 v10, v119, v35
    v_dot2c_f32_bf16 v11, v131, v35
    v_dot2c_f32_bf16 v8, v96, v36
    v_dot2c_f32_bf16 v9, v108, v36
    v_dot2c_f32_bf16 v10, v120, v36
    v_dot2c_f32_bf16 v11, v132, v36
    v_dot2c_f32_bf16 v8, v97, v37
    v_dot2c_f32_bf16 v9, v109, v37
    v_dot2c_f32_bf16 v10, v121, v37
    v_dot2c_f32_bf16 v11, v133, v37
    v_dot2c_f32_bf16 v8, v98, v38
    v_dot2c_f32_bf16 v9, v110, v38
    v_dot2c_f32_bf16 v10, v122, v38
    v_dot2c_f32_bf16 v11, v134, v38
    v_dot2c_f32_bf16 v8, v99, v39
    v_dot2c_f32_bf16 v9, v111, v39
    v_dot2c_f32_bf16 v10, v123, v39
    v_dot2c_f32_bf16 v11, v135, v39
    v_dot2c_f32_bf16 v8, v100, v40
    v_dot2c_f32_bf16 v9, v112, v40
    v_dot2c_f32_bf16 v10, v124, v40
    v_dot2c_f32_bf16 v11, v136, v40
    v_dot2c_f32_bf16 v8, v101, v41
    v_dot2c_f32_bf16 v9, v113, v41
    v_dot2c_f32_bf16 v10, v125, v41
    v_dot2c_f32_bf16 v11, v137, v41
    v_dot2c_f32_bf16 v8, v102, v42
    v_dot2c_f32_bf16 v9, v114, v42
    v_dot2c_f32_bf16 v10, v126, v42
    v_dot2c_f32_bf16 v11, v138, v42
    v_dot2c_f32_bf16 v8, v103, v43
    v_dot2c_f32_bf16 v9, v115, v43
    v_dot2c_f32_bf16 v10, v127, v43
    v_dot2c_f32_bf16 v11, v139, v43
    v_add_f32_dpp v8, v8, v8 quad_perm:[1,0,3,2] row_mask:0xf bank_mask:0xf
    v_add_f32_dpp v9, v9, v9 quad_perm:[1,0,3,2] row_mask:0xf bank_mask:0xf
    v_add_f32_dpp v10, v10, v10 quad_perm:[1,0,3,2] row_mask:0xf bank_mask:0xf
    v_add_f32_dpp v11, v11, v11 quad_perm:[1,0,3,2] row_mask:0xf bank_mask:0xf
    v_add_f32_dpp v8, v8, v8 quad_perm:[2,3,0,1] row_mask:0xf bank_mask:0xf
    v_add_f32_dpp v9, v9, v9 quad_perm:[2,3,0,1] row_mask:0xf bank_mask:0xf
    v_add_f32_dpp v10, v10, v10 quad_perm:[2,3,0,1] row_mask:0xf bank_mask:0xf
    v_add_f32_dpp v11, v11, v11 quad_perm:[2,3,0,1] row_mask:0xf bank_mask:0xf
    v_add_f32_dpp v8, v8, v8 row_half_mirror row_mask:0xf bank_mask:0xf
    v_add_f32_dpp v9, v9, v9 row_half_mirror row_mask:0xf bank_mask:0xf
    v_add_f32_dpp v10, v10, v10 row_half_mirror row_mask:0xf bank_mask:0xf
    v_add_f32_dpp v11, v11, v11 row_half_mirror row_mask:0xf bank_mask:0xf
    ds_write_b128 v3, v[8:11]
    v_add_u32 v3, 16, v3
    buffer_load_dwordx4 v[52:55], v2, s[36:39], s12 offen offset:256 nt
    s_add_u32 s40, s40, 1
    s_and_b32 s40, s40, 15
    s_cselect_b32 s41, s42, 12288
    s_add_u32 s12, s12, s41
    s_add_u32 s54, s54, 1
    s_and_b32 s54, s54, 15
    s_cselect_b32 s41, 0, 3145728
    s_sub_u32 s12, s12, s41
    buffer_load_dwordx4 v[56:59], v2, s[36:39], s12 offen offset:0 nt
    v_dot2_f32_bf16 v8, v140, v32, 0
    v_dot2_f32_bf16 v9, v152, v32, 0
    v_dot2_f32_bf16 v10, v164, v32, 0
    v_dot2_f32_bf16 v11, v176, v32, 0
    v_dot2c_f32_bf16 v8, v141, v33
    v_dot2c_f32_bf16 v9, v153, v33
    v_dot2c_f32_bf16 v10, v165, v33
    v_dot2c_f32_bf16 v11, v177, v33
    v_dot2c_f32_bf16 v8, v142, v34
    v_dot2c_f32_bf16 v9, v154, v34
    v_dot2c_f32_bf16 v10, v166, v34
    v_dot2c_f32_bf16 v11, v178, v34
    v_dot2c_f32_bf16 v8, v143, v35
    v_dot2c_f32_bf16 v9, v155, v35
    v_dot2c_f32_bf16 v10, v167, v35
    v_dot2c_f32_bf16 v11, v179, v35
    v_dot2c_f32_bf16 v8, v144, v36
    v_dot2c_f32_bf16 v9, v156, v36
    v_dot2c_f32_bf16 v10, v168, v36
    v_dot2c_f32_bf16 v11, v180, v36
    v_dot2c_f32_bf16 v8, v145, v37
    v_dot2c_f32_bf16 v9, v157, v37
    v_dot2c_f32_bf16 v10, v169, v37
    v_dot2c_f32_bf16 v11, v181, v37
    v_dot2c_f32_bf16 v8, v146, v38
    v_dot2c_f32_bf16 v9, v158, v38
    v_dot2c_f32_bf16 v10, v170, v38
    v_dot2c_f32_bf16 v11, v182, v38
    v_dot2c_f32_bf16 v8, v147, v39
    v_dot2c_f32_bf16 v9, v159, v39
    v_dot2c_f32_bf16 v10, v171, v39
    v_dot2c_f32_bf16 v11, v183, v39
    v_dot2c_f32_bf16 v8, v148, v40
    v_dot2c_f32_bf16 v9, v160, v40
    v_dot2c_f32_bf16 v10, v172, v40
    v_dot2c_f32_bf16 v11, v184, v40
    v_dot2c_f32_bf16 v8, v149, v41
    v_dot2c_f32_bf16 v9, v161, v41
    v_dot2c_f32_bf16 v10, v173, v41
    v_dot2c_f32_bf16 v11, v185, v41
    v_dot2c_f32_bf16 v8, v150, v42
    v_dot2c_f32_bf16 v9, v162, v42
    v_dot2c_f32_bf16 v10, v174, v42
    v_dot2c_f32_bf16 v11, v186, v42
    v_dot2c_f32_bf16 v8, v151, v43
    v_dot2c_f32_bf16 v9, v163, v43
    v_dot2c_f32_bf16 v10, v175, v43
    v_dot2c_f32_bf16 v11, v187, v43
    v_add_f32_dpp v8, v8, v8 quad_perm:[1,0,3,2] row_mask:0xf bank_mask:0xf
    v_add_f32_dpp v9, v9, v9 quad_perm:[1,0,3,2] row_mask:0xf bank_mask:0xf
    v_add_f32_dpp v10, v10, v10 quad_perm:[1,0,3,2] row_mask:0xf bank_mask:0xf
    v_add_f32_dpp v11, v11, v11 quad_perm:[1,0,3,2] row_mask:0xf bank_mask:0xf
    v_add_f32_dpp v8, v8, v8 quad_perm:[2,3,0,1] row_mask:0xf bank_mask:0xf
    v_add_f32_dpp v9, v9, v9 quad_perm:[2,3,0,1] row_mask:0xf bank_mask:0xf
    v_add_f32_dpp v10, v10, v10 quad_perm:[2,3,0,1] row_mask:0xf bank_mask:0xf
    v_add_f32_dpp v11, v11, v11 quad_perm:[2,3,0,1] row_mask:0xf bank_mask:0xf
    v_add_f32_dpp v8, v8, v8 row_half_mirror row_mask:0xf bank_mask:0xf
    v_add_f32_dpp v9, v9, v9 row_half_mirror row_mask:0xf bank_mask:0xf
    v_add_f32_dpp v10, v10, v10 row_half_mirror row_mask:0xf bank_mask:0xf
    v_add_f32_dpp v11, v11, v11 row_half_mirror row_mask:0xf bank_mask:0xf
    ds_write_b128 v3, v[8:11]
    v_add_u32 v3, 16, v3
    buffer_load_dwordx4 v[60:63], v2, s[36:39], s12 offen offset:128 nt
    buffer_load_dwordx4 v[64:67], v2, s[36:39], s12 offen offset:256 nt
    s_add_u32 s40, s40, 1
    s_and_b32 s40, s40, 15
    s_cselect_b32 s41, s42, 12288
    s_add_u32 s12, s12, s41
    s_add_u32 s54, s54, 1
    s_and_b32 s54, s54, 15
    s_cselect_b32 s41, 0, 3145728
    s_sub_u32 s12, s12, s41
    s_waitcnt vmcnt(6)
    v_dot2_f32_bf16 v8, v188, v32, 0
    v_dot2_f32_bf16 v9, v200, v32, 0
    v_dot2_f32_bf16 v10, v212, v32, 0
    v_dot2_f32_bf16 v11, v224, v32, 0
    v_dot2c_f32_bf16 v8, v189, v33
    v_dot2c_f32_bf16 v9, v201, v33
    v_dot2c_f32_bf16 v10, v213, v33
    v_dot2c_f32_bf16 v11, v225, v33
    v_dot2c_f32_bf16 v8, v190, v34
    v_dot2c_f32_bf16 v9, v202, v34
    v_dot2c_f32_bf16 v10, v214, v34
    v_dot2c_f32_bf16 v11, v226, v34
    v_dot2c_f32_bf16 v8, v191, v35
    v_dot2c_f32_bf16 v9, v203, v35
    v_dot2c_f32_bf16 v10, v215, v35
    v_dot2c_f32_bf16 v11, v227, v35
    v_dot2c_f32_bf16 v8, v192, v36
    v_dot2c_f32_bf16 v9, v204, v36
    v_dot2c_f32_bf16 v10, v216, v36
    v_dot2c_f32_bf16 v11, v228, v36
    v_dot2c_f32_bf16 v8, v193, v37
    v_dot2c_f32_bf16 v9, v205, v37
    v_dot2c_f32_bf16 v10, v217, v37
    v_dot2c_f32_bf16 v11, v229, v37
    v_dot2c_f32_bf16 v8, v194, v38
    v_dot2c_f32_bf16 v9, v206, v38
    v_dot2c_f32_bf16 v10, v218, v38
    v_dot2c_f32_bf16 v11, v230, v38
    v_dot2c_f32_bf16 v8, v195, v39
    v_dot2c_f32_bf16 v9, v207, v39
    v_dot2c_f32_bf16 v10, v219, v39
    v_dot2c_f32_bf16 v11, v231, v39
    v_dot2c_f32_bf16 v8, v196, v40
    v_dot2c_f32_bf16 v9, v208, v40
    v_dot2c_f32_bf16 v10, v220, v40
    v_dot2c_f32_bf16 v11, v232, v40
    v_dot2c_f32_bf16 v8, v197, v41
    v_dot2c_f32_bf16 v9, v209, v41
    v_dot2c_f32_bf16 v10, v221, v41
    v_dot2c_f32_bf16 v11, v233, v41
    v_dot2c_f32_bf16 v8, v198, v42
    v_dot2c_f32_bf16 v9, v210, v42
    v_dot2c_f32_bf16 v10, v222, v42
    v_dot2c_f32_bf16 v11, v234, v42
    v_dot2c_f32_bf16 v8, v199, v43
    v_dot2c_f32_bf16 v9, v211, v43
    v_dot2c_f32_bf16 v10, v223, v43
    v_dot2c_f32_bf16 v11, v235, v43
    v_add_f32_dpp v8, v8, v8 quad_perm:[1,0,3,2] row_mask:0xf bank_mask:0xf
    v_add_f32_dpp v9, v9, v9 quad_perm:[1,0,3,2] row_mask:0xf bank_mask:0xf
    v_add_f32_dpp v10, v10, v10 quad_perm:[1,0,3,2] row_mask:0xf bank_mask:0xf
    v_add_f32_dpp v11, v11, v11 quad_perm:[1,0,3,2] row_mask:0xf bank_mask:0xf
    v_add_f32_dpp v8, v8, v8 quad_perm:[2,3,0,1] row_mask:0xf bank_mask:0xf
    v_add_f32_dpp v9, v9, v9 quad_perm:[2,3,0,1] row_mask:0xf bank_mask:0xf
    v_add_f32_dpp v10, v10, v10 quad_perm:[2,3,0,1] row_mask:0xf bank_mask:0xf
    v_add_f32_dpp v11, v11, v11 quad_perm:[2,3,0,1] row_mask:0xf bank_mask:0xf
    v_add_f32_dpp v8, v8, v8 row_half_mirror row_mask:0xf bank_mask:0xf
    v_add_f32_dpp v9, v9, v9 row_half_mirror row_mask:0xf bank_mask:0xf
    v_add_f32_dpp v10, v10, v10 row_half_mirror row_mask:0xf bank_mask:0xf
    v_add_f32_dpp v11, v11, v11 row_half_mirror row_mask:0xf bank_mask:0xf
    ds_write_b128 v3, v[8:11]
    v_add_u32 v3, 16, v3
    s_waitcnt vmcnt(5)
    buffer_load_dwordx4 v[68:71], v2, s[36:39], s12 offen offset:0 nt
    s_waitcnt vmcnt(5)
    buffer_load_dwordx4 v[72:75], v2, s[36:39], s12 offen offset:128 nt
    v_mov_b32 v236, 0
    v_mov_b32 v238, 1
    s_mov_b32 s52, 0
    v_mov_b32 v239, 0
    s_mov_b32 s43, 0
    s_mov_b64 vcc, 0
    s_mov_b32 s60, 0
    s_mov_b32 s10, 3
L_kphase:
    v_add_u32 v14, 384, v14
    ds_read_b128 v[32:35], v14 offset:0
    ds_read_b128 v[36:39], v14 offset:128
    ds_read_b128 v[40:43], v14 offset:256
    v_add_u32 v3, 448, v3
    s_mov_b32 s11, 4
L_kloop:
    s_waitcnt vmcnt(7)
    s_cbranch_vccnz L_w1
    s_waitcnt vmcnt(5)
    s_cmp_ge_i32 s60, 1
    s_cbranch_scc1 L_w1
    s_waitcnt vmcnt(4)
L_w1:
    buffer_load_dwordx4 v[76:79], v2, s[36:39], s12 offen offset:256 nt
    s_add_u32 s40, s40, 1
    s_and_b32 s40, s40, 15
    s_cselect_b32 s41, s42, 12288
    s_add_u32 s12, s12, s41
    s_add_u32 s54, s54, 1
    s_and_b32 s54, s54, 15
    s_cselect_b32 s41, 0, 3145728
    s_sub_u32 s12, s12, s41
    s_waitcnt vmcnt(7)
    s_cbranch_vccnz L_w2
    s_waitcnt vmcnt(5)
    s_cmp_ge_i32 s60, 1
    s_cbranch_scc1 L_w2
    s_waitcnt vmcnt(4)
L_w2:
    buffer_load_dwordx4 v[80:83], v2, s[36:39], s12 offen offset:0 nt
    s_waitcnt vmcnt(7) lgkmcnt(0)
    s_cbranch_vccnz L_w3
    s_waitcnt vmcnt(5)
    s_cmp_ge_i32 s60, 1
    s_cbranch_scc1 L_w3
    s_waitcnt vmcnt(4)
L_w3:
    buffer_load_dwordx4 v[84:87], v2, s[36:39], s12 offen offset:128 nt
    s_mov_b64 exec, 1
    ds_add_u32 v239, v238 offset:1856
    s_mov_b64 exec, -1
    s_add_u32 s43, s43, 4
    v_dot2_f32_bf16 v12, v44, v32, 0
    v_dot2_f32_bf16 v13, v45, v33, 0
    v_dot2_f32_bf16 v12, v46, v34, v12
    v_dot2_f32_bf16 v13, v47, v35, v13
    v_dot2_f32_bf16 v12, v48, v36, v12
    v_dot2_f32_bf16 v13, v49, v37, v13
    v_dot2_f32_bf16 v12, v50, v38, v12
    v_dot2_f32_bf16 v13, v51, v39, v13
    v_dot2_f32_bf16 v12, v52, v40, v12
    v_dot2_f32_bf16 v13, v53, v41, v13
    v_dot2_f32_bf16 v12, v54, v42, v12
    v_dot2_f32_bf16 v13, v55, v43, v13
    s_nop 2
    v_add_f32 v12, v12, v13
    s_nop 1
    v_add_f32_dpp v12, v12, v12 quad_perm:[1,0,3,2] row_mask:0xf bank_mask:0xf
    s_nop 1
    v_add_f32_dpp v12, v12, v12 quad_perm:[2,3,0,1] row_mask:0xf bank_mask:0xf
    s_nop 1
    v_add_f32_dpp v8, v12, v12 row_half_mirror row_mask:0xf bank_mask:0xf
    s_waitcnt vmcnt(7)
    s_cbranch_vccnz L_w4
    s_waitcnt vmcnt(5)
    s_cmp_ge_i32 s60, 1
    s_cbranch_scc1 L_w4
    s_waitcnt vmcnt(4)
L_w4:
    buffer_load_dwordx4 v[88:91], v2, s[36:39], s12 offen offset:256 nt
    s_add_u32 s40, s40, 1
    s_and_b32 s40, s40, 15
    s_cselect_b32 s41, s42, 12288
    s_add_u32 s12, s12, s41
    s_add_u32 s54, s54, 1
    s_and_b32 s54, s54, 15
    s_cselect_b32 s41, 0, 3145728
    s_sub_u32 s12, s12, s41
    s_sub_u32 s5, s5, 1
    s_cmp_lg_u32 s5, 0
    s_cbranch_scc1 L_seg1
    s_mov_b32 s5, 4
    s_lshr_b32 s55, s55, 4
    s_and_b32 s41, s55, 15
    s_sub_u32 s54, s41, s54
    s_mul_i32 s54, s54, 196608
    s_add_u32 s12, s12, s54
    s_mov_b32 s54, s41
    s_add_u32 s12, s12, 50331648
    s_cmp_lt_u32 s12, 201326592
    s_cbranch_scc1 L_seg1
    s_sub_u32 s12, s12, 201326592
    s_mov_b32 s36, s20
    s_mov_b32 s37, s21
L_seg1:
    s_waitcnt vmcnt(7)
    s_cbranch_vccnz L_w5
    s_waitcnt vmcnt(5)
    s_cmp_ge_i32 s60, 1
    s_cbranch_scc1 L_w5
    s_waitcnt vmcnt(4)
L_w5:
    buffer_load_dwordx4 v[44:47], v2, s[36:39], s12 offen offset:0 nt
    ds_read_b64 v[236:237], v239 offset:1856
    s_waitcnt vmcnt(7) lgkmcnt(0)
    s_cbranch_vccnz L_w6
    s_waitcnt vmcnt(5)
    s_cmp_ge_i32 s60, 1
    s_cbranch_scc1 L_w6
    s_waitcnt vmcnt(4)
L_w6:
    buffer_load_dwordx4 v[48:51], v2, s[36:39], s12 offen offset:128 nt
    v_readfirstlane_b32 s53, v237
    v_readfirstlane_b32 s59, v236
    s_sub_u32 s53, s53, s43
    s_add_u32 s53, s53, s59
    s_mov_b32 s60, s53
    s_cmp_gt_i32 s53, 5
    s_cselect_b64 vcc, -1, 0
    s_cmp_ge_u32 s43, 428
    s_cselect_b64 vcc, -1, vcc
    s_mov_b64 exec, 1
    ds_add_u32 v239, v238 offset:1856
    s_mov_b64 exec, -1
    s_add_u32 s43, s43, 4
    v_dot2_f32_bf16 v12, v56, v32, 0
    v_dot2_f32_bf16 v13, v57, v33, 0
    v_dot2_f32_bf16 v12, v58, v34, v12
    v_dot2_f32_bf16 v13, v59, v35, v13
    v_dot2_f32_bf16 v12, v60, v36, v12
    v_dot2_f32_bf16 v13, v61, v37, v13
    v_dot2_f32_bf16 v12, v62, v38, v12
    v_dot2_f32_bf16 v13, v63, v39, v13
    v_dot2_f32_bf16 v12, v64, v40, v12
    v_dot2_f32_bf16 v13, v65, v41, v13
    v_dot2_f32_bf16 v12, v66, v42, v12
    v_dot2_f32_bf16 v13, v67, v43, v13
    s_nop 2
    v_add_f32 v12, v12, v13
    s_nop 1
    v_add_f32_dpp v12, v12, v12 quad_perm:[1,0,3,2] row_mask:0xf bank_mask:0xf
    s_nop 1
    v_add_f32_dpp v12, v12, v12 quad_perm:[2,3,0,1] row_mask:0xf bank_mask:0xf
    s_nop 1
    v_add_f32_dpp v9, v12, v12 row_half_mirror row_mask:0xf bank_mask:0xf
    s_waitcnt vmcnt(7)
    s_cbranch_vccnz L_w7
    s_waitcnt vmcnt(5)
    s_cmp_ge_i32 s60, 1
    s_cbranch_scc1 L_w7
    s_waitcnt vmcnt(4)
L_w7:
    buffer_load_dwordx4 v[52:55], v2, s[36:39], s12 offen offset:256 nt
    s_add_u32 s40, s40, 1
    s_and_b32 s40, s40, 15
    s_cselect_b32 s41, s42, 12288
    s_add_u32 s12, s12, s41
    s_add_u32 s54, s54, 1
    s_and_b32 s54, s54, 15
    s_cselect_b32 s41, 0, 3145728
    s_sub_u32 s12, s12, s41
    s_waitcnt vmcnt(7)
    s_cbranch_vccnz L_w8
    s_waitcnt vmcnt(5)
    s_cmp_ge_i32 s60, 1
    s_cbranch_scc1 L_w8
    s_waitcnt vmcnt(4)
L_w8:
    buffer_load_dwordx4 v[56:59], v2, s[36:39], s12 offen offset:0 nt
    s_waitcnt vmcnt(7)
    s_cbranch_vccnz L_w9
    s_waitcnt vmcnt(5)
    s_cmp_ge_i32 s60, 1
    s_cbranch_scc1 L_w9
    s_waitcnt vmcnt(4)
L_w9:
    buffer_load_dwordx4 v[60:63], v2, s[36:39], s12 offen offset:128 nt
    s_mov_b64 exec, 1
    ds_add_u32 v239, v238 offset:1856
    s_mov_b64 exec, -1
    s_add_u32 s43, s43, 4
    v_dot2_f32_bf16 v12, v68, v32, 0
    v_dot2_f32_bf16 v13, v69, v33, 0
    v_dot2_f32_bf16 v12, v70, v34, v12
    v_dot2_f32_bf16 v13, v71, v35, v13
    v_dot2_f32_bf16 v12, v72, v36, v12
    v_dot2_f32_bf16 v13, v73, v37, v13
    v_dot2_f32_bf16 v12, v74, v38, v12
    v_dot2_f32_bf16 v13, v75, v39, v13
    v_dot2_f32_bf16 v12, v76, v40, v12
    v_dot2_f32_bf16 v13, v77, v41, v13
    v_dot2_f32_bf16 v12, v78, v42, v12
    v_dot2_f32_bf16 v13, v79, v43, v13
    s_nop 2
    v_add_f32 v12, v12, v13
    s_nop 1
    v_add_f32_dpp v12, v12, v12 quad_perm:[1,0,3,2] row_mask:0xf bank_mask:0xf
    s_nop 1
    v_add_f32_dpp v12, v12, v12 quad_perm:[2,3,0,1] row_mask:0xf bank_mask:0xf
    s_nop 1
    v_add_f32_dpp v10, v12, v12 row_half_mirror row_mask:0xf bank_mask:0xf
    s_waitcnt vmcnt(7)
    s_cbranch_vccnz L_w10
    s_waitcnt vmcnt(5)
    s_cmp_ge_i32 s60, 1
    s_cbranch_scc1 L_w10
    s_waitcnt vmcnt(4)
L_w10:
    buffer_load_dwordx4 v[64:67], v2, s[36:39], s12 offen offset:256 nt
    s_add_u32 s40, s40, 1
    s_and_b32 s40, s40, 15
    s_cselect_b32 s41, s42, 12288
    s_add_u32 s12, s12, s41
    s_add_u32 s54, s54, 1
    s_and_b32 s54, s54, 15
    s_cselect_b32 s41, 0, 3145728
    s_sub_u32 s12, s12, s41
    s_waitcnt vmcnt(7)
    s_cbranch_vccnz L_w11
    s_waitcnt vmcnt(5)
    s_cmp_ge_i32 s60, 1
    s_cbranch_scc1 L_w11
    s_waitcnt vmcnt(4)
L_w11:
    buffer_load_dwordx4 v[68:71], v2, s[36:39], s12 offen offset:0 nt
    ds_read_b64 v[236:237], v239 offset:1856
    s_waitcnt vmcnt(7) lgkmcnt(0)
    s_cbranch_vccnz L_w12
    s_waitcnt vmcnt(5)
    s_cmp_ge_i32 s60, 1
    s_cbranch_scc1 L_w12
    s_waitcnt vmcnt(4)
L_w12:
    buffer_load_dwordx4 v[72:75], v2, s[36:39], s12 offen offset:128 nt
    v_readfirstlane_b32 s53, v237
    v_readfirstlane_b32 s59, v236
    s_sub_u32 s53, s53, s43
    s_add_u32 s53, s53, s59
    s_mov_b32 s60, s53
    s_cmp_gt_i32 s53, 5
    s_cselect_b64 vcc, -1, 0
    s_cmp_ge_u32 s43, 428
    s_cselect_b64 vcc, -1, vcc
    s_mov_b64 exec, 1
    ds_add_u32 v239, v238 offset:1856
    s_mov_b64 exec, -1
    s_add_u32 s43, s43, 4
    v_dot2_f32_bf16 v12, v80, v32, 0
    v_dot2_f32_bf16 v13, v81, v33, 0
    v_dot2_f32_bf16 v12, v82, v34, v12
    v_dot2_f32_bf16 v13, v83, v35, v13
    v_dot2_f32_bf16 v12, v84, v36, v12
    v_dot2_f32_bf16 v13, v85, v37, v13
    v_dot2_f32_bf16 v12, v86, v38, v12
    v_dot2_f32_bf16 v13, v87, v39, v13
    v_dot2_f32_bf16 v12, v88, v40, v12
    v_dot2_f32_bf16 v13, v89, v41, v13
    v_dot2_f32_bf16 v12, v90, v42, v12
    v_dot2_f32_bf16 v13, v91, v43, v13
    s_nop 2
    v_add_f32 v12, v12, v13
    s_nop 1
    v_add_f32_dpp v12, v12, v12 quad_perm:[1,0,3,2] row_mask:0xf bank_mask:0xf
    s_nop 1
    v_add_f32_dpp v12, v12, v12 quad_perm:[2,3,0,1] row_mask:0xf bank_mask:0xf
    s_nop 1
    v_add_f32_dpp v11, v12, v12 row_half_mirror row_mask:0xf bank_mask:0xf
    ds_write_b128 v3, v[8:11]
    v_add_u32 v3, 16, v3
    s_sub_u32 s11, s11, 1
    s_cmp_lg_u32 s11, 0
    s_cbranch_scc1 L_kloop
    s_sub_u32 s10, s10, 1
    s_cmp_lg_u32 s10, 0
    s_cbranch_scc1 L_kphase
    v_lshl_add_u32 v15, v1, 5, s6
    ds_read_b128 v[92:95], v15
    ds_read_b128 v[96:99], v15 offset:16
    buffer_load_dwordx4 v[76:79], v2, s[36:39], s12 offen offset:256 nt
    s_add_u32 s40, s40, 1
    s_and_b32 s40, s40, 15
    s_cselect_b32 s41, s42, 12288
    s_add_u32 s12, s12, s41
    s_add_u32 s54, s54, 1
    s_and_b32 s54, s54, 15
    s_cselect_b32 s41, 0, 3145728
    s_sub_u32 s12, s12, s41
    buffer_load_dwordx4 v[80:83], v2, s[36:39], s12 offen offset:0 nt
    buffer_load_dwordx4 v[84:87], v2, s[36:39], s12 offen offset:128 nt
    v_lshrrev_b32 v3, 3, v1
    v_lshl_add_u32 v3, v3, 6, s6
    v_lshrrev_b32 v12, 4, v1
    v_lshlrev_b32 v12, 5, v12
    v_lshl_add_u32 v12, s8, 2, v12
    v_and_b32 v14, 7, v1
    v_lshlrev_b32 v14, 5, v14
    v_and_b32 v13, 16, v1
    v_add_u32 v14, v14, v13
    v_lshrrev_b32 v13, 5, v1
    v_mul_u32_u24 v13, 768, v13
    s_mul_i32 s10, s8, 1536
    s_add_u32 s10, s10, 17408
    v_add3_u32 v14, v14, v13, s10
    s_waitcnt lgkmcnt(0)
    v_cvt_pk_bf16_f32 v92, v92, v93
    v_cvt_pk_bf16_f32 v94, v94, v95
    v_cvt_pk_bf16_f32 v96, v96, v97
    v_cvt_pk_bf16_f32 v98, v98, v99
    v_and_b32 v93, s13, v92
    v_lshlrev_b32 v92, 16, v92
    v_and_b32 v95, s13, v94
    v_lshlrev_b32 v94, 16, v94
    v_and_b32 v97, s13, v96
    v_lshlrev_b32 v96, 16, v96
    v_and_b32 v99, s13, v98
    v_lshlrev_b32 v98, 16, v98
    v_mul_f32 v92, s14, v92
    v_mul_f32 v93, s14, v93
    v_mul_f32 v94, s14, v94
    v_mul_f32 v95, s14, v95
    v_mul_f32 v96, s14, v96
    v_mul_f32 v97, s14, v97
    v_mul_f32 v98, s14, v98
    v_mul_f32 v99, s14, v99
    v_cvt_pk_bf16_f32 v92, v92, v93
    v_cvt_pk_bf16_f32 v94, v94, v95
    v_cvt_pk_bf16_f32 v96, v96, v97
    v_cvt_pk_bf16_f32 v98, v98, v99
    v_and_b32 v93, s13, v92
    v_lshlrev_b32 v92, 16, v92
    v_and_b32 v95, s13, v94
    v_lshlrev_b32 v94, 16, v94
    v_and_b32 v97, s13, v96
    v_lshlrev_b32 v96, 16, v96
    v_and_b32 v99, s13, v98
    v_lshlrev_b32 v98, 16, v98
    v_max3_f32 v100, v92, v93, v94
    v_max3_f32 v101, v95, v96, v97
    v_max3_f32 v100, v100, v98, v99
    v_max_f32 v100, v100, v101
    s_nop 1
    v_max_f32_dpp v100, v100, v100 quad_perm:[1,0,3,2] row_mask:0xf bank_mask:0xf
    s_nop 1
    v_max_f32_dpp v100, v100, v100 quad_perm:[2,3,0,1] row_mask:0xf bank_mask:0xf
    s_nop 1
    v_max_f32_dpp v100, v100, v100 row_half_mirror row_mask:0xf bank_mask:0xf
    s_nop 1
    v_max_f32_dpp v100, v100, v100 row_ror:8 row_mask:0xf bank_mask:0xf
    v_sub_f32 v92, v92, v100
    v_sub_f32 v93, v93, v100
    v_sub_f32 v94, v94, v100
    v_sub_f32 v95, v95, v100
    v_sub_f32 v96, v96, v100
    v_sub_f32 v97, v97, v100
    v_sub_f32 v98, v98, v100
    v_sub_f32 v99, v99, v100
    v_mul_f32 v92, s15, v92
    v_mul_f32 v93, s15, v93
    v_mul_f32 v94, s15, v94
    v_mul_f32 v95, s15, v95
    v_mul_f32 v96, s15, v96
    v_mul_f32 v97, s15, v97
    v_mul_f32 v98, s15, v98
    v_mul_f32 v99, s15, v99
    v_exp_f32 v92, v92
    v_exp_f32 v93, v93
    v_exp_f32 v94, v94
    v_exp_f32 v95, v95
    v_exp_f32 v96, v96
    v_exp_f32 v97, v97
    v_exp_f32 v98, v98
    v_exp_f32 v99, v99
    v_add_f32 v101, v92, v93
    v_add_f32 v101, v101, v94
    v_add_f32 v101, v101, v95
    v_add_f32 v101, v101, v96
    v_add_f32 v101, v101, v97
    v_add_f32 v101, v101, v98
    v_add_f32 v101, v101, v99
    v_cvt_pk_bf16_f32 v92, v92, v92
    v_cvt_pk_bf16_f32 v93, v93, v93
    v_cvt_pk_bf16_f32 v94, v94, v94
    v_cvt_pk_bf16_f32 v95, v95, v95
    v_cvt_pk_bf16_f32 v96, v96, v96
    v_cvt_pk_bf16_f32 v97, v97, v97
    v_cvt_pk_bf16_f32 v98, v98, v98
    v_cvt_pk_bf16_f32 v99, v99, v99
    ds_write_b128 v15, v[92:95]
    ds_write_b128 v15, v[96:99] offset:16
    ds_read_b128 v[8:11], v3
    v_add_u32 v3, 16, v3
    v_add_f32_dpp v101, v101, v101 quad_perm:[1,0,3,2] row_mask:0xf bank_mask:0xf
    s_nop 1
    v_add_f32_dpp v101, v101, v101 quad_perm:[2,3,0,1] row_mask:0xf bank_mask:0xf
    s_nop 1
    v_add_f32_dpp v101, v101, v101 row_half_mirror row_mask:0xf bank_mask:0xf
    s_nop 1
    v_add_f32_dpp v101, v101, v101 row_ror:8 row_mask:0xf bank_mask:0xf
    ds_write_b32 v12, v100 offset:1536
    ds_write_b32 v12, v101 offset:1552
    v_mov_b32 v12, 0
    v_mov_b32 v13, 1
    s_mov_b64 exec, 1
    ds_add_u32 v12, v13 offset:1792
    s_mov_b64 exec, -1
    s_mov_b32 s10, 4
    s_mov_b32 s11, 4
    s_mov_b64 exec, 1
    ds_add_u32 v239, v238 offset:1856
    s_mov_b64 exec, -1
    s_add_u32 s43, s43, 4
    s_waitcnt vmcnt(8) lgkmcnt(0)
    v_and_b32 v16, v8, v4
    v_and_b32 v17, v8, v5
    v_and_b32 v18, v8, v6
    v_and_b32 v19, v8, v7
    s_nop 1
    v_mfma_f32_16x16x32_bf16 v[20:23], v[16:19], v[44:47], v[20:23]
    v_mfma_f32_16x16x32_bf16 v[24:27], v[16:19], v[48:51], v[24:27]
    v_mfma_f32_16x16x32_bf16 v[28:31], v[16:19], v[52:55], v[28:31]
    s_branch L_vloop_mid
L_vphase:
    v_mov_b32 v20, 0
    v_mov_b32 v21, 0
    v_mov_b32 v22, 0
    v_mov_b32 v23, 0
    v_mov_b32 v24, 0
    v_mov_b32 v25, 0
    v_mov_b32 v26, 0
    v_mov_b32 v27, 0
    v_mov_b32 v28, 0
    v_mov_b32 v29, 0
    v_mov_b32 v30, 0
    v_mov_b32 v31, 0
    v_add_u32 v14, 6144, v14
    v_add_u32 v3, 448, v3
    v_add_u32 v12, 4, v12
    s_mov_b32 s11, 4
L_vloop:
    ds_read_b128 v[8:11], v3
    v_add_u32 v3, 16, v3
    s_waitcnt vmcnt(7)
    s_cbranch_vccnz L_w13
    s_waitcnt vmcnt(5)
    s_cmp_ge_i32 s60, 1
    s_cbranch_scc1 L_w13
    s_waitcnt vmcnt(4)
L_w13:
    buffer_load_dwordx4 v[76:79], v2, s[36:39], s12 offen offset:256 nt
    s_add_u32 s40, s40, 1
    s_and_b32 s40, s40, 15
    s_cselect_b32 s41, s42, 12288
    s_add_u32 s12, s12, s41
    s_add_u32 s54, s54, 1
    s_and_b32 s54, s54, 15
    s_cselect_b32 s41, 0, 3145728
    s_sub_u32 s12, s12, s41
    s_waitcnt vmcnt(7)
    s_cbranch_vccnz L_w14
    s_waitcnt vmcnt(5)
    s_cmp_ge_i32 s60, 1
    s_cbranch_scc1 L_w14
    s_waitcnt vmcnt(4)
L_w14:
    buffer_load_dwordx4 v[80:83], v2, s[36:39], s12 offen offset:0 nt
    s_waitcnt vmcnt(7) lgkmcnt(0)
    s_cbranch_vccnz L_w15
    s_waitcnt vmcnt(5)
    s_cmp_ge_i32 s60, 1
    s_cbranch_scc1 L_w15
    s_waitcnt vmcnt(4)
L_w15:
    buffer_load_dwordx4 v[84:87], v2, s[36:39], s12 offen offset:128 nt
    s_mov_b64 exec, 1
    ds_add_u32 v239, v238 offset:1856
    s_mov_b64 exec, -1
    s_add_u32 s43, s43, 4
    v_and_b32 v16, v8, v4
    v_and_b32 v17, v8, v5
    v_and_b32 v18, v8, v6
    v_and_b32 v19, v8, v7
    s_nop 1
    v_mfma_f32_16x16x32_bf16 v[20:23], v[16:19], v[44:47], v[20:23]
    v_mfma_f32_16x16x32_bf16 v[24:27], v[16:19], v[48:51], v[24:27]
    v_mfma_f32_16x16x32_bf16 v[28:31], v[16:19], v[52:55], v[28:31]
L_vloop_mid:
    s_waitcnt vmcnt(7)
    s_cbranch_vccnz L_w16
    s_waitcnt vmcnt(5)
    s_cmp_ge_i32 s60, 1
    s_cbranch_scc1 L_w16
    s_waitcnt vmcnt(4)
L_w16:
    buffer_load_dwordx4 v[88:91], v2, s[36:39], s12 offen offset:256 nt
    s_add_u32 s40, s40, 1
    s_and_b32 s40, s40, 15
    s_cselect_b32 s41, s42, 12288
    s_add_u32 s12, s12, s41
    s_add_u32 s54, s54, 1
    s_and_b32 s54, s54, 15
    s_cselect_b32 s41, 0, 3145728
    s_sub_u32 s12, s12, s41
    s_sub_u32 s5, s5, 1
    s_cmp_lg_u32 s5, 0
    s_cbranch_scc1 L_seg2
    s_mov_b32 s5, 4
    s_lshr_b32 s55, s55, 4
    s_and_b32 s41, s55, 15
    s_sub_u32 s54, s41, s54
    s_mul_i32 s54, s54, 196608
    s_add_u32 s12, s12, s54
    s_mov_b32 s54, s41
    s_add_u32 s12, s12, 50331648
L_seg2:
    s_lshl_b32 s53, s10, 3
    s_or_b32 s53, s53, s11
    s_cmp_lg_u32 s53, 9
    s_cbranch_scc1 L_nopre
    s_mov_b64 exec, 1
    ds_add_u32 v12, v13 offset:1808
    s_mov_b64 exec, -1
L_nopre:
    s_waitcnt vmcnt(7)
    s_cbranch_vccnz L_w17
    s_waitcnt vmcnt(5)
    s_cmp_ge_i32 s60, 1
    s_cbranch_scc1 L_w17
    s_waitcnt vmcnt(4)
L_w17:
    buffer_load_dwordx4 v[44:47], v2, s[36:39], s12 offen offset:0 nt
    ds_read_b64 v[236:237], v239 offset:1856
    s_waitcnt vmcnt(7) lgkmcnt(0)
    s_cbranch_vccnz L_w18
    s_waitcnt vmcnt(5)
    s_cmp_ge_i32 s60, 1
    s_cbranch_scc1 L_w18
    s_waitcnt vmcnt(4)
L_w18:
    buffer_load_dwordx4 v[48:51], v2, s[36:39], s12 offen offset:128 nt
    v_readfirstlane_b32 s53, v237
    v_readfirstlane_b32 s59, v236
    s_sub_u32 s53, s53, s43
    s_add_u32 s53, s53, s59
    s_mov_b32 s60, s53
    s_cmp_gt_i32 s53, 5
    s_cselect_b64 vcc, -1, 0
    s_cmp_ge_u32 s43, 428
    s_cselect_b64 vcc, -1, vcc
    s_mov_b64 exec, 1
    ds_add_u32 v239, v238 offset:1856
    s_mov_b64 exec, -1
    s_add_u32 s43, s43, 4
    v_and_b32 v16, v9, v4
    v_and_b32 v17, v9, v5
    v_and_b32 v18, v9, v6
    v_and_b32 v19, v9, v7
    s_nop 1
    v_mfma_f32_16x16x32_bf16 v[20:23], v[16:19], v[56:59], v[20:23]
    v_mfma_f32_16x16x32_bf16 v[24:27], v[16:19], v[60:63], v[24:27]
    v_mfma_f32_16x16x32_bf16 v[28:31], v[16:19], v[64:67], v[28:31]
    s_waitcnt vmcnt(7)
    s_cbranch_vccnz L_w19
    s_waitcnt vmcnt(5)
    s_cmp_ge_i32 s60, 1
    s_cbranch_scc1 L_w19
    s_waitcnt vmcnt(4)
L_w19:
    buffer_load_dwordx4 v[52:55], v2, s[36:39], s12 offen offset:256 nt
    s_add_u32 s40, s40, 1
    s_and_b32 s40, s40, 15
    s_cselect_b32 s41, s42, 12288
    s_add_u32 s12, s12, s41
    s_add_u32 s54, s54, 1
    s_and_b32 s54, s54, 15
    s_cselect_b32 s41, 0, 3145728
    s_sub_u32 s12, s12, s41
    s_waitcnt vmcnt(7)
    s_cbranch_vccnz L_w20
    s_waitcnt vmcnt(5)
    s_cmp_ge_i32 s60, 1
    s_cbranch_scc1 L_w20
    s_waitcnt vmcnt(4)
L_w20:
    buffer_load_dwordx4 v[56:59], v2, s[36:39], s12 offen offset:0 nt
    s_waitcnt vmcnt(7)
    s_cbranch_vccnz L_w21
    s_waitcnt vmcnt(5)
    s_cmp_ge_i32 s60, 1
    s_cbranch_scc1 L_w21
    s_waitcnt vmcnt(4)
L_w21:
    buffer_load_dwordx4 v[60:63], v2, s[36:39], s12 offen offset:128 nt
    s_mov_b64 exec, 1
    ds_add_u32 v239, v238 offset:1856
    s_mov_b64 exec, -1
    s_add_u32 s43, s43, 4
    v_and_b32 v16, v10, v4
    v_and_b32 v17, v10, v5
    v_and_b32 v18, v10, v6
    v_and_b32 v19, v10, v7
    s_nop 1
    v_mfma_f32_16x16x32_bf16 v[20:23], v[16:19], v[68:71], v[20:23]
    v_mfma_f32_16x16x32_bf16 v[24:27], v[16:19], v[72:75], v[24:27]
    v_mfma_f32_16x16x32_bf16 v[28:31], v[16:19], v[76:79], v[28:31]
    s_waitcnt vmcnt(7)
    s_cbranch_vccnz L_w22
    s_waitcnt vmcnt(5)
    s_cmp_ge_i32 s60, 1
    s_cbranch_scc1 L_w22
    s_waitcnt vmcnt(4)
L_w22:
    buffer_load_dwordx4 v[64:67], v2, s[36:39], s12 offen offset:256 nt
    s_add_u32 s40, s40, 1
    s_and_b32 s40, s40, 15
    s_cselect_b32 s41, s42, 12288
    s_add_u32 s12, s12, s41
    s_add_u32 s54, s54, 1
    s_and_b32 s54, s54, 15
    s_cselect_b32 s41, 0, 3145728
    s_sub_u32 s12, s12, s41
    s_waitcnt vmcnt(7)
    s_cbranch_vccnz L_w23
    s_waitcnt vmcnt(5)
    s_cmp_ge_i32 s60, 1
    s_cbranch_scc1 L_w23
    s_waitcnt vmcnt(4)
L_w23:
    buffer_load_dwordx4 v[68:71], v2, s[36:39], s12 offen offset:0 nt
    ds_read_b64 v[236:237], v239 offset:1856
    s_waitcnt vmcnt(7) lgkmcnt(0)
    s_cbranch_vccnz L_w24
    s_waitcnt vmcnt(5)
    s_cmp_ge_i32 s60, 1
    s_cbranch_scc1 L_w24
    s_waitcnt vmcnt(4)
L_w24:
    buffer_load_dwordx4 v[72:75], v2, s[36:39], s12 offen offset:128 nt
    v_readfirstlane_b32 s53, v237
    v_readfirstlane_b32 s59, v236
    s_sub_u32 s53, s53, s43
    s_add_u32 s53, s53, s59
    s_mov_b32 s60, s53
    s_cmp_gt_i32 s53, 5
    s_cselect_b64 vcc, -1, 0
    s_cmp_ge_u32 s43, 428
    s_cselect_b64 vcc, -1, vcc
    s_mov_b64 exec, 1
    ds_add_u32 v239, v238 offset:1856
    s_mov_b64 exec, -1
    s_add_u32 s43, s43, 4
    v_and_b32 v16, v11, v4
    v_and_b32 v17, v11, v5
    v_and_b32 v18, v11, v6
    v_and_b32 v19, v11, v7
    s_nop 1
    v_mfma_f32_16x16x32_bf16 v[20:23], v[16:19], v[80:83], v[20:23]
    v_mfma_f32_16x16x32_bf16 v[24:27], v[16:19], v[84:87], v[24:27]
    v_mfma_f32_16x16x32_bf16 v[28:31], v[16:19], v[88:91], v[28:31]
    s_sub_u32 s11, s11, 1
    s_cmp_lg_u32 s11, 0
    s_cbranch_scc1 L_vloop
    s_mov_b32 exec_lo, 0x00ff00ff
    s_mov_b32 exec_hi, 0xff00ff00
    s_nop 0
    ds_write_b128 v14, v[20:23] offset:0
    ds_write_b128 v14, v[24:27] offset:256
    ds_write_b128 v14, v[28:31] offset:512
    s_mov_b64 exec, 1
    ds_add_u32 v12, v13 offset:1796
    s_mov_b64 exec, -1
    s_sub_u32 s10, s10, 1
    s_cmp_lg_u32 s10, 0
    s_cbranch_scc1 L_vphase
L_fin:
L_end:
    s_endpgm
.section .rodata,"a"
.p2align 6
.amdhsa_kernel parallel_sum__mha_block_cached__dense_activation_relu__decode_kernel
  .amdhsa_next_free_vgpr 240
  .amdhsa_next_free_sgpr 102
  .amdhsa_accum_offset 240
  .amdhsa_group_segment_fixed_size 0
  .amdhsa_kernarg_size 88
  .amdhsa_user_sgpr_count 2
  .amdhsa_user_sgpr_kernarg_segment_ptr 1
  .amdhsa_system_sgpr_workgroup_id_x 1
  .amdhsa_float_denorm_mode_32 3
.end_amdhsa_kernel
```
